```python
import torch

def _softmax(x, axis=-1):
    return torch.softmax(x, dim=axis)
def _gelu(x):
    return torch.nn.functional.gelu(x, approximate="tanh")
def _silu(x):
    return torch.nn.functional.silu(x)
def _sigmoid(x):
    return torch.sigmoid(x)
def _layernorm(x, axis=-1, eps=1e-5):
    m = x.mean(dim=axis, keepdim=True)
    v = x.var(dim=axis, keepdim=True, unbiased=False)
    return (x - m) / torch.sqrt(v + eps)
def _scatter_add(tgt, idx, src, axis=0):
    return tgt.clone().index_add_(axis, idx, src)
def _segment_sum(src, seg, n):
    out = torch.zeros((n,) + src.shape[1:], dtype=src.dtype)
    return out.index_add_(0, seg, src)
def _pad(x, pw):
    flat = tuple(v for pair in reversed(pw) for v in pair)
    return torch.nn.functional.pad(x, flat)

kernel_name = 'sequential_preLN__linear_attn_block__mixer_token_mlp__prompt'

def setup_inputs():

    _w = (lambda a: (lambda t: t.to(torch.bfloat16) if t.is_floating_point() else t)(torch.as_tensor(a)))
    def _A_setup():
        B, S, D = 1, 2048, 640
        return {
            "x": _w((lambda *s: torch.randn(*s, dtype=torch.bfloat16) * 0.05)(B, S, D)),
            "wqkv": _w((lambda *s: torch.randn(*s, dtype=torch.bfloat16) * 0.05)(D, 3 * D)),
            "wo": _w((lambda *s: torch.randn(*s, dtype=torch.bfloat16) * 0.05)(D, D)),
        }
    _A_in = _A_setup()

    def _B_setup():
        B, S, D, F = 1, 2048, 640, 1536
        return {
            "x": _w((lambda *s: torch.randn(*s, dtype=torch.bfloat16) * 0.05)(B, S, D)),
            "w1": _w((lambda *s: torch.randn(*s, dtype=torch.bfloat16) * 0.2)(S, F) * (S ** -0.5)),
            "b1": _w((lambda *s: torch.randn(*s, dtype=torch.bfloat16) * 3.2)(F) * 0.02),
            "w2": _w((lambda *s: torch.randn(*s, dtype=torch.bfloat16) * 0.4)(F, S) * (F ** -0.5)),
            "b2": _w((lambda *s: torch.randn(*s, dtype=torch.bfloat16) * 0.8)(S) * 0.02),
        }
    _B_in = _B_setup()

    return {
        "A_x": _A_in["x"],
        "A_wqkv": _A_in["wqkv"],
        "A_wo": _A_in["wo"],
        "B_x": _B_in["x"],
        "B_w1": _B_in["w1"],
        "B_b1": _B_in["b1"],
        "B_w2": _B_in["w2"],
        "B_b2": _B_in["b2"],
    }

def reference(A_x, A_wqkv, A_wo, B_x, B_w1, B_b1, B_w2, B_b2):
    def _A_ref(x, wqkv, wo):
        B, S, D = x.shape
        H = 32; Dh = D // H
        qkv = (lambda x, *d: x.permute(*d))((x @ wqkv).reshape(B, S, 3, H, Dh), 2, 0, 3, 1, 4)
        q, k, v = qkv[0], qkv[1], qkv[2]
        phi = lambda t: torch.where(t > 0, t + 1, torch.exp(t)) + 1e-6
        pq, pk = phi(q), phi(k)
        kv = torch.einsum("bhsd,bhse->bhde", pk, v)
        z = torch.einsum("bhsd->bhd", pk)
        num = torch.einsum("bhqd,bhde->bhqe", pq, kv)
        den = torch.einsum("bhqd,bhd->bhq", pq, z)[..., None] + 1e-6
        o = num / den
        return (lambda x, *d: x.permute(*d))(o, 0, 2, 1, 3).reshape(B, S, D) @ wo

    def _B_ref(x, w1, b1, w2, b2):
        B, S, D = x.shape
        h = _layernorm(x, axis=-1)
        u = torch.einsum("bsd,sf->bdf", h, w1) + b1
        u = _gelu(u)
        y = torch.einsum("bdf,fs->bds", u, w2) + b2
        return (lambda x, *d: x.permute(*d))(y, 0, 2, 1)

    x = A_x
    h = x + _A_ref(_layernorm(x, axis=-1), A_wqkv, A_wo)
    h2 = h + _B_ref(_layernorm(h, axis=-1), B_w1, B_b1, B_w2, B_b2)
    return h2
```

```asm
; @launch grid=(256,1,1) block=(256,1,1) lds=163840
.amdgcn_target "amdgcn-amd-amdhsa--gfx950"
.text
.globl sequential_preLN__linear_attn_block__mixer_token_mlp__prompt_kernel
.p2align 8
.type sequential_preLN__linear_attn_block__mixer_token_mlp__prompt_kernel,@function
sequential_preLN__linear_attn_block__mixer_token_mlp__prompt_kernel:
    s_load_dwordx16 s[4:19], s[0:1], 0
    s_load_dwordx4 s[24:27], s[0:1], 64
    s_load_dwordx2 s[28:29], s[0:1], 80
    s_cmpk_ge_u32 s2, 0x100
    s_cbranch_scc1 L_end
    s_getpc_b64 s[60:61]
    s_lshr_b32 s45, s2, 3
    v_lshl_add_u32 v7, s45, 8, v0
    v_lshlrev_b32 v7, 3, v7
    global_load_dword v254, v7, s[60:61]
    v_lshrrev_b32 v8, 6, v0
    v_and_b32 v1, 63, v0
    v_readfirstlane_b32 s38, v8
    v_lshlrev_b32 v4, 4, v1
    s_mul_i32 s88, s2, 171
    s_lshr_b32 s88, s88, 11
    s_mul_i32 s89, s88, 12
    s_sub_u32 s89, s2, s89
    s_lshr_b32 s89, s89, 2
    s_and_b32 s90, s2, 3
    s_lshl2_add_u32 s90, s90, s38
    s_mul_i32 s66, s88, 122880
    s_mul_i32 s50, s89, 1280
    s_add_u32 s66, s66, s50
    s_mul_i32 s50, s90, 80
    s_add_u32 s66, s66, s50
    s_mul_i32 s52, s38, 12928
    s_add_u32 s53, s52, 120320
    s_mov_b32 s22, 2457600
    s_mov_b32 s23, 0x20000
    s_mov_b32 s30, 16777216
    s_mov_b32 s31, 0x20000
    s_movk_i32 s97, 3840
    s_movk_i32 s3, -80
    v_mul_u32_u24 v8, 205, v1
    v_lshrrev_b32 v8, 10, v8
    v_lshlrev_b32 v7, 4, v1
    v_mad_i32_i24 v7, v8, s3, v7
    v_and_b32 v9, 1, v8
    v_bfe_u32 v10, v8, 1, 2
    v_lshl_add_u32 v9, v9, 2, v10
    v_and_or_b32 v8, v8, 24, v9
    v_mad_u32_u24 v16, v8, s97, v7
    v_add_u32 v7, 64, v1
    v_mul_u32_u24 v8, 205, v7
    v_lshrrev_b32 v8, 10, v8
    v_lshlrev_b32 v7, 4, v7
    v_mad_i32_i24 v7, v8, s3, v7
    v_and_b32 v9, 1, v8
    v_bfe_u32 v10, v8, 1, 2
    v_lshl_add_u32 v9, v9, 2, v10
    v_and_or_b32 v8, v8, 24, v9
    v_mad_u32_u24 v17, v8, s97, v7
    v_add_u32 v7, 128, v1
    v_mul_u32_u24 v8, 205, v7
    v_lshrrev_b32 v8, 10, v8
    v_lshlrev_b32 v7, 4, v7
    v_mad_i32_i24 v7, v8, s3, v7
    v_and_b32 v9, 1, v8
    v_bfe_u32 v10, v8, 1, 2
    v_lshl_add_u32 v9, v9, 2, v10
    v_and_or_b32 v8, v8, 24, v9
    v_mad_u32_u24 v18, v8, s97, v7
    v_mov_b32 v64, 0
    v_mov_b32 v65, 0
    v_mov_b32 v66, 0
    v_mov_b32 v67, 0
    s_lshl2_add_u32 s54, s2, s38
    s_sub_u32 s54, s54, 960
    s_lshl_b32 s55, s54, 11
    s_cmp_lt_u32 s54, 15
    s_cselect_b32 s55, s55, 0x2000000
    s_cselect_b32 s100, 1, 0
    s_waitcnt lgkmcnt(0)
    s_mov_b64 s[20:21], s[6:7]
    buffer_store_dwordx4 v[64:67], v4, s[28:31], s55 offen offset:0 sc1
    buffer_store_dwordx4 v[64:67], v4, s[28:31], s55 offen offset:1024 sc1
    s_add_u32 m0, s53, 0
    s_nop 0
    buffer_load_dwordx4 v16, s[20:23], s66 offen lds
    s_add_u32 m0, s53, 1024
    s_nop 0
    buffer_load_dwordx4 v17, s[20:23], s66 offen lds
    s_add_u32 m0, s53, 2048
    s_mov_b32 exec_hi, 0
    buffer_load_dwordx4 v18, s[20:23], s66 offen lds
    s_mov_b32 exec_hi, -1
    s_and_b32 s46, s2, 1
    s_bfe_u32 s47, s2, 0x20001
    s_lshr_b32 s48, s45, 3
    s_and_b32 s49, s45, 7
    s_lshl2_add_u32 s39, s47, s48
    s_lshl3_add_u32 s40, s46, s49
    s_lshl_b32 s50, s49, 2
    s_lshr_b32 s56, 0x42086420, s50
    s_and_b32 s56, s56, 15
    s_mul_i32 s99, s39, 163840
    s_lshl_b32 s64, s56, 7
    s_add_u32 s64, s64, s99
    s_add_u32 s65, s99, 1280
    s_add_u32 s52, s52, 112128
    s_mov_b32 s6, 2621440
    s_mov_b32 s7, 0x20000
    v_lshrrev_b32 v7, 3, v1
    v_and_b32 v8, 7, v1
    v_lshrrev_b32 v2, 4, v1
    v_xor_b32 v8, v8, v2
    v_lshlrev_b32 v8, 4, v8
    v_lshl_add_u32 v7, s38, 5, v7
    v_mul_u32_u24 v7, 1280, v7
    v_add_u32 v12, v7, v8
    v_xor_b32 v13, 64, v12
    v_add_u32 v13, 9216, v13
    v_add_u32 v14, 18432, v12
    v_add_u32 v15, 18432, v13
    s_lshl_b32 s101, s38, 12
    s_add_u32 m0, s101, 45056
    s_nop 0
    buffer_load_dwordx4 v12, s[4:7], s64 offen offset:0 lds
    buffer_load_dwordx4 v13, s[4:7], s64 offen offset:1024 lds
    buffer_load_dwordx4 v14, s[4:7], s64 offen offset:2048 lds
    buffer_load_dwordx4 v15, s[4:7], s64 offen offset:3072 lds
    s_cmp_ge_u32 s88, 20
    s_cselect_b32 s78, 0x2000000, 0
    s_and_b32 s50, s88, 3
    s_lshl2_add_u32 s71, s90, s50
    s_lshl_b32 s71, s71, 7
    s_add_u32 s71, s71, 0
    s_add_u32 s71, s71, s78
    s_mul_i32 s77, s90, 3
    s_add_u32 s77, s77, s89
    s_mul_i32 s77, s77, 20
    s_add_u32 s77, s77, s88
    s_lshl_b32 s77, s77, 8
    s_add_u32 s77, s77, 393216
    s_add_u32 s77, s77, s78
    s_mul_i32 s90, s90, 153600
    s_add_u32 s90, s90, 13631488
    s_add_u32 s90, s90, s78
    s_mul_i32 s68, s88, 3072
    s_mul_i32 s50, s88, 2560
    s_add_u32 s50, s50, 102400
    s_cmp_eq_u32 s89, 0
    s_cselect_b32 s68, s50, s68
    s_cselect_b32 s51, 128, 0
    s_lshl_b32 s50, s88, 11
    s_add_u32 s50, s50, 61440
    s_cmp_eq_u32 s89, 2
    s_cselect_b32 s67, s50, s68
    s_cselect_b32 s98, 8, 0
    s_lshl_b32 s98, 0x00ff00ff, s98
    s_add_u32 s67, s67, s90
    s_add_u32 s68, s68, s90
    v_mul_u32_u24 v7, s51, v2
    v_sub_u32 v25, v4, v7
    v_lshrrev_b32 v7, 2, v1
    v_mul_u32_u24 v7, 160, v7
    v_add_u32 v7, s53, v7
    v_and_b32 v8, 3, v1
    v_lshl_add_u32 v22, v8, 3, v7
    v_and_b32 v8, 1, v1
    v_mul_u32_u24 v8, 40, v8
    v_add3_u32 v23, v7, v8, 32
    v_and_b32 v3, 15, v1
    v_mov_b32 v5, 1
    v_lshlrev_b32 v32, 2, v1
    s_mov_b64 s[36:37], s[26:27]
    s_cmp_lt_u32 s54, 4
    s_cselect_b32 s50, 0, 28
    s_add_u32 s54, s54, s50
    s_and_b32 s54, s54, 63
    s_lshl_b32 s54, s54, 2
    v_mov_b32 v50, s54
    v_lshrrev_b32 v7, 1, v3
    v_xor_b32 v7, v7, v2
    v_lshlrev_b32 v7, 4, v7
    v_lshlrev_b32 v8, 7, v3
    v_add3_u32 v26, v7, v8, s52
    v_xor_b32 v27, 64, v26
    v_add3_u32 v20, v7, v8, s101
    v_add_u32 v20, 45056, v20
    v_xor_b32 v21, 64, v20
    v_mov_b32 v68, 0x3f803f80
    v_mov_b32 v69, 0x3f803f80
    v_mov_b32 v70, 0x3f803f80
    v_mov_b32 v71, 0x3f803f80
    s_cmp_eq_u32 s100, 0
    s_cbranch_scc1 L_noraise_1
    s_waitcnt vmcnt(7)
    s_mov_b64 exec, 1
    global_store_dword v50, v5, s[36:37] sc1
    s_mov_b64 exec, -1
L_noraise_1:
    s_mov_b64 s[32:33], s[14:15]
    s_mov_b64 s[34:35], s[18:19]
    s_mov_b32 s14, 6291456
    s_mov_b32 s15, 0x20000
    s_mov_b32 s18, 6291456
    s_mov_b32 s19, 0x20000
    s_mov_b32 s26, 2621440
    s_mov_b32 s27, 0x20000
    v_mov_b32 v6, 0
    s_lshr_b32 s41, s45, 2
    s_lshl3_add_u32 s41, s47, s41
    s_and_b32 s42, s49, 3
    s_lshl2_add_u32 s42, s46, s42
    s_lshl2_add_u32 s92, s41, s38
    s_lshl2_add_u32 s50, s40, s38
    s_lshl_b32 s90, s50, 7
    s_add_u32 s73, s90, 0
    s_add_u32 s90, s90, 12288
    s_lshl_b32 s91, s50, 13
    s_add_u32 s91, s91, 1048576
    s_lshl_b32 s93, s39, 9
    s_add_u32 s93, s93, s91
    v_lshlrev_b32 v60, s39, v5
    s_mul_i32 s75, s40, 153600
    s_add_u32 s75, s75, 13631488
    s_lshl_b32 s56, s56, 1
    s_sub_u32 s76, s38, s56
    s_and_b32 s76, s76, 3
    s_add_u32 s56, s56, s76
    s_add_u32 s66, s56, 4
    s_cmp_ge_u32 s66, 20
    s_cselect_b32 s50, 20, 0
    s_sub_u32 s66, s66, s50
    s_add_u32 s69, s66, 4
    s_cmp_ge_u32 s69, 20
    s_cselect_b32 s50, 20, 0
    s_sub_u32 s69, s69, s50
    s_add_u32 s55, s69, 4
    s_cmp_ge_u32 s55, 20
    s_cselect_b32 s50, 20, 0
    s_sub_u32 s55, s55, s50
    s_add_u32 s54, s55, 4
    s_cmp_ge_u32 s54, 20
    s_cselect_b32 s50, 20, 0
    s_sub_u32 s54, s54, s50
    s_lshl2_add_u32 s74, s42, s38
    s_lshl_b32 s74, s74, 7
    s_add_u32 s74, s74, 8192
    s_mul_i32 s1, s42, 102400
    s_lshl_b32 s53, s38, 10
    s_add_u32 s1, s1, s53
    s_add_u32 s1, s1, 10485760
    v_lshrrev_b32 v7, 3, v0
    v_lshl_add_u32 v7, s45, 5, v7
    v_and_b32 v8, 7, v1
    v_lshl_add_u32 v9, s47, 3, v8
    v_lshlrev_b32 v9, 7, v9
    s_lshl2_add_u32 s50, s45, s38
    s_lshl_b32 s50, s50, 13
    v_lshl_add_u32 v31, v7, 12, v9
    v_subrev_u32 v31, s50, v31
    v_min_u32 v8, 5, v8
    s_mul_i32 s50, s47, 768
    v_lshl_add_u32 v8, v8, 7, s50
    v_mul_u32_u24 v7, 3072, v7
    v_add_u32 v30, v7, v8
    s_cmp_ge_u32 s45, 14
    s_cselect_b32 s50, -2, 18
    s_cmp_ge_u32 s45, 12
    s_cselect_b32 s50, s50, 0
    s_add_u32 s45, s45, s50
    s_mul_i32 s50, s45, 52
    s_lshr_b32 s50, s50, 8
    s_mul_i32 s44, s47, 6
    s_add_u32 s44, s44, s50
    s_mul_i32 s50, s50, 5
    s_sub_u32 s43, s45, s50
    s_mul_i32 s50, s46, 5
    s_add_u32 s43, s43, s50
    s_cmp_ge_u32 s45, 30
    s_cselect_b32 s44, 0, s44
    s_lshl_b32 s46, s38, 7
    s_add_u32 s46, s46, 103936
    v_lshl_add_u32 v35, v3, 2, s46
    v_lshl_add_u32 v34, v2, 4, s46
    v_lshrrev_b32 v10, 2, v3
    v_cmp_eq_u32 s[82:83], v10, v2
    v_mov_b32 v9, 104448
    s_nop 0
    v_cndmask_b32 v33, v9, v35, s[82:83]
    v_cmp_eq_u32 s[84:85], 0, v2
    v_cmp_eq_u32 s[86:87], 1, v2
    s_mov_b32 s58, 0x358637bd
    s_mov_b32 s59, 0x358637bd
    s_mov_b32 s48, 0x3acccccd
    s_mov_b32 s49, 0x3727c5ac
    s_mov_b32 s51, 0x3fb8aa3b
    v_add_u32 v28, 61440, v4
    v_add_u32 v53, 112128, v4
    v_and_b32 v7, 7, v1
    v_lshlrev_b32 v7, 4, v7
    v_lshl_add_u32 v7, v2, 7, v7
    v_add_u32 v54, 114176, v7
    s_mul_i32 s46, s40, 3
    s_add_u32 s46, s46, s38
    s_mul_i32 s46, s46, 5120
    s_add_u32 s46, s46, 393216
    s_cmp_eq_u32 s38, 3
    s_cselect_b32 s46, 0x2000000, s46
    v_add_u32 v29, s46, v4
    v_add_u32 v52, 4096, v29
    s_mov_b32 s10, 819200
    s_mov_b32 s11, 0x20000
    s_cmp_lt_u32 s2, 56
    s_cselect_b32 s0, 0x2000000, 0
    s_max_u32 s88, s2, 56
    s_sub_u32 s88, s88, 56
    s_mul_i32 s89, s88, 205
    s_lshr_b32 s89, s89, 11
    s_mul_i32 s50, s89, 10
    s_sub_u32 s88, s88, s50
    s_lshl2_add_u32 s88, s88, s38
    s_mul_i32 s50, s89, 40
    s_mul_i32 s79, s89, 160
    s_sub_u32 s79, s79, 2544
    s_cmp_lt_u32 s89, 16
    s_cselect_b32 s50, s50, s79
    s_cmp_lt_u32 s89, 16
    s_cselect_b32 s79, 4, 40
    s_mul_i32 s97, s50, 1280
    s_lshl_b32 s50, s88, 5
    s_add_u32 s97, s97, s50
    s_waitcnt vmcnt(4)
    ds_read_b64_tr_b16 v[104:105], v22 offset:0
    ds_read_b64_tr_b16 v[106:107], v22 offset:80
    ds_read_b64_tr_b16 v[108:109], v22 offset:40
    ds_read_b64_tr_b16 v[110:111], v22 offset:120
    ds_read_b64_tr_b16 v[112:113], v23 offset:0
    ds_read_b64_tr_b16 v[114:115], v23 offset:80
    s_waitcnt lgkmcnt(4)
    v_mfma_f32_16x16x32_bf16 v[116:119], v[68:71], v[104:107], 0
    buffer_store_dwordx4 v[104:107], v4, s[28:31], s67 offen offset:0 sc1
    s_waitcnt lgkmcnt(2)
    v_mfma_f32_16x16x32_bf16 v[120:123], v[68:71], v[108:111], 0
    buffer_store_dwordx4 v[108:111], v4, s[28:31], s67 offen offset:1024 sc1
    s_waitcnt lgkmcnt(0)
    v_mfma_f32_16x16x32_bf16 v[124:127], v[68:71], v[112:115], 0
    s_mov_b32 exec_lo, s98
    s_mov_b32 exec_hi, s98
    buffer_store_dwordx4 v[112:115], v25, s[28:31], s68 offen offset:2048 sc1
    s_mov_b64 exec, 0xffff
    s_nop 0
    v_mov_b32 v117, v120
    s_nop 1
    v_mov_b32 v118, v124
    buffer_store_dwordx4 v[116:119], v4, s[28:31], s77 offen sc1
    s_mov_b64 exec, -1
    s_add_u32 s64, s64, 128
    s_cmp_eq_u32 s64, s65
    s_cselect_b32 s64, s99, s64
    s_add_u32 m0, s101, 61440
    s_nop 0
    buffer_load_dwordx4 v12, s[4:7], s64 offen offset:0 lds
    buffer_load_dwordx4 v13, s[4:7], s64 offen offset:1024 lds
    buffer_load_dwordx4 v14, s[4:7], s64 offen offset:2048 lds
    buffer_load_dwordx4 v15, s[4:7], s64 offen offset:3072 lds
    s_add_u32 s97, s97, s0
    v_bfe_u32 v7, v1, 3, 2
    v_bfe_u32 v8, v1, 1, 2
    v_mad_u32_u24 v7, v7, s79, v8
    v_lshrrev_b32 v8, 5, v1
    v_mad_u32_u24 v7, v8, 20, v7
    v_mul_u32_u24 v7, 1280, v7
    v_and_b32 v8, 1, v1
    v_lshl_add_u32 v19, v8, 4, v7
    v_add_u32 v19, s97, v19
    s_mul_i32 s70, s88, 20
    s_add_u32 s70, s70, s89
    s_lshl_b32 s70, s70, 10
    s_add_u32 s70, s70, 10485760
    s_add_u32 s70, s70, s0
    s_mul_i32 s72, s88, 52
    s_lshr_b32 s72, s72, 8
    s_and_b32 s50, s89, 3
    s_lshl2_add_u32 s72, s72, s50
    s_lshl_b32 s72, s72, 7
    s_add_u32 s72, s72, 8192
    s_add_u32 s72, s72, s0
    v_lshl_add_u32 v24, v1, 3, s53
    v_add_u32 v24, 108032, v24
    v_lshlrev_b32 v7, 4, v3
    v_add_u32 v56, 108032, v4
    v_add_u32 v55, s53, v56
    v_lshl_add_u32 v49, v2, 3, v7
    v_add_u32 v7, 86016, v4
    v_lshl_add_u32 v36, s38, 10, v7
    v_lshl_add_u32 v37, s38, 12, v7
    v_lshlrev_b32 v7, 3, v1
    v_add_u32 v38, 105472, v7
    v_mov_b32 v8, 107520
    v_add_u32 v7, 107008, v7
    ds_write_b64 v8, v[64:65]
    v_cmp_eq_u32 s[60:61], 0, v10
    v_cmp_eq_u32 s[62:63], 1, v10
    v_cndmask_b32 v39, v8, v7, s[84:85]
    v_cndmask_b32 v40, v8, v7, s[86:87]
    v_add_u32 v9, 1088, v38
    v_cndmask_b32 v41, v8, v9, s[60:61]
    v_cndmask_b32 v42, v8, v9, s[62:63]
    v_add_u32 v9, 320, v7
    s_and_b64 s[60:61], s[60:61], s[84:85]
    s_and_b64 s[62:63], s[62:63], s[86:87]
    v_cndmask_b32 v43, v8, v9, s[60:61]
    v_cndmask_b32 v44, v8, v9, s[62:63]
    v_lshlrev_b32 v9, 7, v2
    s_add_u32 m0, s53, 108032
    v_add_u32 v45, 106496, v9
    buffer_load_dwordx4 v19, s[8:11], 0 offen lds
    v_add_u32 v9, 107264, v9
    v_cndmask_b32 v46, v8, v9, s[84:85]
    v_cndmask_b32 v47, v8, v9, s[86:87]
    v_lshl_add_u32 v48, s38, 9, v38
    s_mul_i32 s46, s42, 160
    s_movk_i32 s3, 1120
    v_add_u32 v7, 0, v1
    v_mul_u32_u24 v8, 205, v7
    v_lshrrev_b32 v8, 11, v8
    v_lshl_add_u32 v7, v7, 4, s46
    v_mad_u32_u24 v57, v8, s3, v7
    v_add_u32 v7, 64, v1
    v_mul_u32_u24 v8, 205, v7
    v_lshrrev_b32 v8, 11, v8
    v_lshl_add_u32 v7, v7, 4, s46
    v_mad_u32_u24 v58, v8, s3, v7
    v_add_u32 v7, 128, v1
    v_mul_u32_u24 v8, 205, v7
    v_lshrrev_b32 v8, 11, v8
    v_lshl_add_u32 v7, v7, 4, s46
    v_mad_u32_u24 v59, v8, s3, v7
    v_and_b32 v7, 3, v3
    v_cmp_eq_u32 s[60:61], 1, v7
    v_cmp_eq_u32 s[62:63], 2, v7
    v_cmp_eq_u32 s[82:83], 3, v7
    v_mov_b32 v232, -1
    v_mov_b32 v233, -1
    v_mov_b32 v234, -1
    v_mov_b32 v235, -1
    s_lshl2_add_u32 s88, s2, s38
    s_lshl_b32 s88, s88, 10
    s_add_u32 s88, s88, 36864
    s_cmp_ge_u32 s2, 24
    s_cselect_b32 s88, 0x2000000, s88
    s_lshl3_add_u32 s89, s92, s42
    s_lshl_b32 s89, s89, 7
    s_add_u32 s89, s89, 196608
    s_lshl_b32 s46, s44, 7
    s_lshl_b32 s47, s38, 5
    s_add_u32 s46, s46, s47
    v_lshl_add_u32 v16, v2, 3, s46
    s_lshl_b32 s46, s92, 5
    v_lshl_add_u32 v17, v3, 1, s46
    s_load_dwordx4 s[20:23], s[36:37], 0
    s_waitcnt vmcnt(9)
    ds_read_b128 a[0:3], v20 offset:0
    ds_read_b128 a[4:7], v20 offset:2048
    ds_read_b128 a[8:11], v21 offset:0
    ds_read_b128 a[12:15], v21 offset:2048
    s_waitcnt lgkmcnt(0)
    s_and_b64 s[20:21], s[20:21], s[22:23]
    s_mov_b32 s57, 0
    s_and_b32 s20, s20, s21
    s_cbranch_scc0 L_gospin_3
L_go_2:
    s_waitcnt vmcnt(5)
    s_mov_b64 exec, 1
    buffer_atomic_add v5, off, s[28:31], s71 sc1
    s_mov_b64 exec, -1
    s_add_u32 s64, s64, 128
    s_cmp_eq_u32 s64, s65
    s_cselect_b32 s64, s99, s64
    s_add_u32 m0, s101, 77824
    s_nop 0
    buffer_load_dwordx4 v12, s[4:7], s64 offen offset:0 lds
    buffer_load_dwordx4 v13, s[4:7], s64 offen offset:1024 lds
    buffer_load_dwordx4 v14, s[4:7], s64 offen offset:2048 lds
    buffer_load_dwordx4 v15, s[4:7], s64 offen offset:3072 lds
    v_mfma_f32_16x16x32_bf16 v[152:155], v[68:71], a[0:3], 0
    s_add_u32 s64, s64, 128
    s_cmp_eq_u32 s64, s65
    s_cselect_b32 s64, s99, s64
    v_mfma_f32_16x16x32_bf16 v[160:163], a[0:3], a[0:3], 0
    s_add_u32 m0, s52, 0
    v_mfma_f32_16x16x32_bf16 v[156:159], v[68:71], a[4:7], 0
    buffer_load_dwordx4 v12, s[4:7], s64 offen offset:0 lds
    v_mfma_f32_16x16x32_bf16 v[164:167], a[4:7], a[4:7], 0
    buffer_load_dwordx4 v13, s[4:7], s64 offen offset:1024 lds
    v_mfma_f32_16x16x32_bf16 v[152:155], v[68:71], a[8:11], v[152:155]
    buffer_load_dwordx4 v14, s[4:7], s64 offen offset:2048 lds
    v_mfma_f32_16x16x32_bf16 v[160:163], a[8:11], a[8:11], v[160:163]
    buffer_load_dwordx4 v15, s[4:7], s64 offen offset:3072 lds
    v_mfma_f32_16x16x32_bf16 v[156:159], v[68:71], a[12:15], v[156:159]
    v_mfma_f32_16x16x32_bf16 v[164:167], a[12:15], a[12:15], v[164:167]
    s_waitcnt vmcnt(10)
    ds_read_b128 a[16:19], v20 offset:16384
    ds_read_b128 a[20:23], v20 offset:18432
    ds_read_b128 a[24:27], v21 offset:16384
    ds_read_b128 a[28:31], v21 offset:18432
    s_waitcnt vmcnt(9)
    ds_read_b64_tr_b16 v[180:181], v24 offset:0
    ds_read_b64_tr_b16 v[182:183], v24 offset:512
    s_waitcnt lgkmcnt(2)
    v_mfma_f32_16x16x32_bf16 v[152:155], v[68:71], a[16:19], v[152:155]
    s_add_u32 s64, s64, 128
    s_cmp_eq_u32 s64, s65
    s_cselect_b32 s64, s99, s64
    s_add_u32 m0, s52, 4096
    v_mfma_f32_16x16x32_bf16 v[160:163], a[16:19], a[16:19], v[160:163]
    buffer_load_dwordx4 v12, s[4:7], s64 offen offset:0 lds
    v_mfma_f32_16x16x32_bf16 v[156:159], v[68:71], a[20:23], v[156:159]
    buffer_load_dwordx4 v13, s[4:7], s64 offen offset:1024 lds
    v_mfma_f32_16x16x32_bf16 v[164:167], a[20:23], a[20:23], v[164:167]
    buffer_load_dwordx4 v14, s[4:7], s64 offen offset:2048 lds
    v_mfma_f32_16x16x32_bf16 v[152:155], v[68:71], a[24:27], v[152:155]
    buffer_load_dwordx4 v15, s[4:7], s64 offen offset:3072 lds
    v_mfma_f32_16x16x32_bf16 v[160:163], a[24:27], a[24:27], v[160:163]
    s_waitcnt vmcnt(8)
    ds_read_b128 a[32:35], v20 offset:32768
    v_mfma_f32_16x16x32_bf16 v[156:159], v[68:71], a[28:31], v[156:159]
    ds_read_b128 a[36:39], v20 offset:34816
    ds_read_b128 a[40:43], v21 offset:32768
    v_mfma_f32_16x16x32_bf16 v[164:167], a[28:31], a[28:31], v[164:167]
    ds_read_b128 a[44:47], v21 offset:34816
    s_waitcnt lgkmcnt(0)
    v_mfma_f32_16x16x32_bf16 v[152:155], v[68:71], a[32:35], v[152:155]
    s_add_u32 s64, s64, 128
    s_cmp_eq_u32 s64, s65
    s_cselect_b32 s64, s99, s64
    s_add_u32 m0, s52, 8192
    v_mfma_f32_16x16x32_bf16 v[160:163], a[32:35], a[32:35], v[160:163]
    buffer_load_dwordx4 v12, s[4:7], s64 offen offset:0 lds
    v_mfma_f32_16x16x32_bf16 v[156:159], v[68:71], a[36:39], v[156:159]
    buffer_load_dwordx4 v13, s[4:7], s64 offen offset:1024 lds
    v_mfma_f32_16x16x32_bf16 v[164:167], a[36:39], a[36:39], v[164:167]
    buffer_load_dwordx4 v14, s[4:7], s64 offen offset:2048 lds
    v_mfma_f32_16x16x32_bf16 v[152:155], v[68:71], a[40:43], v[152:155]
    buffer_load_dwordx4 v15, s[4:7], s64 offen offset:3072 lds
    v_mfma_f32_16x16x32_bf16 v[160:163], a[40:43], a[40:43], v[160:163]
    s_waitcnt vmcnt(8)
    ds_read_b128 a[48:51], v26 offset:0
    v_mfma_f32_16x16x32_bf16 v[156:159], v[68:71], a[44:47], v[156:159]
    ds_read_b128 a[52:55], v26 offset:2048
    ds_read_b128 a[56:59], v27 offset:0
    v_mfma_f32_16x16x32_bf16 v[164:167], a[44:47], a[44:47], v[164:167]
    ds_read_b128 a[60:63], v27 offset:2048
    s_waitcnt lgkmcnt(0)
    v_mfma_f32_16x16x32_bf16 v[152:155], v[68:71], a[48:51], v[152:155]
    s_add_u32 s64, s64, 128
    s_cmp_eq_u32 s64, s65
    s_cselect_b32 s64, s99, s64
    s_add_u32 m0, s101, 45056
    v_mfma_f32_16x16x32_bf16 v[160:163], a[48:51], a[48:51], v[160:163]
    buffer_load_dwordx4 v12, s[4:7], s64 offen offset:0 lds
    v_mfma_f32_16x16x32_bf16 v[156:159], v[68:71], a[52:55], v[156:159]
    buffer_load_dwordx4 v13, s[4:7], s64 offen offset:1024 lds
    v_mfma_f32_16x16x32_bf16 v[164:167], a[52:55], a[52:55], v[164:167]
    buffer_load_dwordx4 v14, s[4:7], s64 offen offset:2048 lds
    v_mfma_f32_16x16x32_bf16 v[152:155], v[68:71], a[56:59], v[152:155]
    buffer_load_dwordx4 v15, s[4:7], s64 offen offset:3072 lds
    v_mfma_f32_16x16x32_bf16 v[160:163], a[56:59], a[56:59], v[160:163]
    s_waitcnt vmcnt(8)
    ds_read_b128 a[64:67], v26 offset:4096
    v_mfma_f32_16x16x32_bf16 v[156:159], v[68:71], a[60:63], v[156:159]
    ds_read_b128 a[68:71], v26 offset:6144
    ds_read_b128 a[72:75], v27 offset:4096
    v_mfma_f32_16x16x32_bf16 v[164:167], a[60:63], a[60:63], v[164:167]
    ds_read_b128 a[76:79], v27 offset:6144
    v_mov_b32 v51, 0
    s_mov_b64 exec, 1
    buffer_atomic_add v51, v6, s[28:31], s73 offen sc0 sc1
    s_mov_b64 exec, -1
    s_waitcnt lgkmcnt(0)
    v_mfma_f32_16x16x32_bf16 v[152:155], v[68:71], a[64:67], v[152:155]
    s_add_u32 s64, s64, 128
    s_cmp_eq_u32 s64, s65
    s_cselect_b32 s64, s99, s64
    s_add_u32 m0, s101, 61440
    v_mfma_f32_16x16x32_bf16 v[160:163], a[64:67], a[64:67], v[160:163]
    buffer_load_dwordx4 v12, s[4:7], s64 offen offset:0 lds
    v_mfma_f32_16x16x32_bf16 v[156:159], v[68:71], a[68:71], v[156:159]
    buffer_load_dwordx4 v13, s[4:7], s64 offen offset:1024 lds
    v_mfma_f32_16x16x32_bf16 v[164:167], a[68:71], a[68:71], v[164:167]
    buffer_load_dwordx4 v14, s[4:7], s64 offen offset:2048 lds
    v_mfma_f32_16x16x32_bf16 v[152:155], v[68:71], a[72:75], v[152:155]
    buffer_load_dwordx4 v15, s[4:7], s64 offen offset:3072 lds
    v_mfma_f32_16x16x32_bf16 v[160:163], a[72:75], a[72:75], v[160:163]
    s_waitcnt vmcnt(9)
    ds_read_b128 a[80:83], v26 offset:8192
    v_mfma_f32_16x16x32_bf16 v[156:159], v[68:71], a[76:79], v[156:159]
    ds_read_b128 a[84:87], v26 offset:10240
    ds_read_b128 a[88:91], v27 offset:8192
    v_mfma_f32_16x16x32_bf16 v[164:167], a[76:79], a[76:79], v[164:167]
    ds_read_b128 a[92:95], v27 offset:10240
    s_waitcnt lgkmcnt(0)
    v_mfma_f32_16x16x32_bf16 v[152:155], v[68:71], a[80:83], v[152:155]
    s_add_u32 s64, s64, 128
    s_cmp_eq_u32 s64, s65
    s_cselect_b32 s64, s99, s64
    s_add_u32 m0, s101, 77824
    v_mfma_f32_16x16x32_bf16 v[160:163], a[80:83], a[80:83], v[160:163]
    buffer_load_dwordx4 v12, s[4:7], s64 offen offset:0 lds
    v_mfma_f32_16x16x32_bf16 v[156:159], v[68:71], a[84:87], v[156:159]
    buffer_load_dwordx4 v13, s[4:7], s64 offen offset:1024 lds
    v_mfma_f32_16x16x32_bf16 v[164:167], a[84:87], a[84:87], v[164:167]
    buffer_load_dwordx4 v14, s[4:7], s64 offen offset:2048 lds
    v_mfma_f32_16x16x32_bf16 v[152:155], v[68:71], a[88:91], v[152:155]
    buffer_load_dwordx4 v15, s[4:7], s64 offen offset:3072 lds
    v_mfma_f32_16x16x32_bf16 v[160:163], a[88:91], a[88:91], v[160:163]
    s_waitcnt vmcnt(9)
    ds_read_b128 a[96:99], v20 offset:0
    v_mfma_f32_16x16x32_bf16 v[156:159], v[68:71], a[92:95], v[156:159]
    ds_read_b128 a[100:103], v20 offset:2048
    ds_read_b128 a[104:107], v21 offset:0
    v_mfma_f32_16x16x32_bf16 v[164:167], a[92:95], a[92:95], v[164:167]
    ds_read_b128 a[108:111], v21 offset:2048
    s_waitcnt lgkmcnt(0)
    v_mfma_f32_16x16x32_bf16 v[152:155], v[68:71], a[96:99], v[152:155]
    s_add_u32 s64, s64, 128
    s_cmp_eq_u32 s64, s65
    s_cselect_b32 s64, s99, s64
    s_add_u32 m0, s52, 0
    v_mfma_f32_16x16x32_bf16 v[160:163], a[96:99], a[96:99], v[160:163]
    buffer_load_dwordx4 v12, s[4:7], s64 offen offset:0 lds
    v_mfma_f32_16x16x32_bf16 v[156:159], v[68:71], a[100:103], v[156:159]
    buffer_load_dwordx4 v13, s[4:7], s64 offen offset:1024 lds
    v_mfma_f32_16x16x32_bf16 v[164:167], a[100:103], a[100:103], v[164:167]
    buffer_load_dwordx4 v14, s[4:7], s64 offen offset:2048 lds
    v_mfma_f32_16x16x32_bf16 v[152:155], v[68:71], a[104:107], v[152:155]
    buffer_load_dwordx4 v15, s[4:7], s64 offen offset:3072 lds
    v_mfma_f32_16x16x32_bf16 v[160:163], a[104:107], a[104:107], v[160:163]
    s_waitcnt vmcnt(8)
    ds_read_b128 a[112:115], v20 offset:16384
    v_mfma_f32_16x16x32_bf16 v[156:159], v[68:71], a[108:111], v[156:159]
    ds_read_b128 a[116:119], v20 offset:18432
    ds_read_b128 a[120:123], v21 offset:16384
    v_mfma_f32_16x16x32_bf16 v[164:167], a[108:111], a[108:111], v[164:167]
    ds_read_b128 a[124:127], v21 offset:18432
    v_cmp_gt_u32 vcc, 15, v51
    s_mov_b32 s57, 0
    s_and_b32 vcc_lo, vcc_lo, 1
    s_cbranch_scc1 L_slow_P_4
L_back_P_5:
    s_waitcnt lgkmcnt(0)
    v_mfma_f32_16x16x32_bf16 v[152:155], v[68:71], a[112:115], v[152:155]
    s_mul_i32 s78, s76, 3072
    s_mul_i32 s77, s56, 3072
    s_add_u32 s77, s77, s75
    s_add_u32 m0, s78, 0
    v_mfma_f32_16x16x32_bf16 v[160:163], a[112:115], a[112:115], v[160:163]
    buffer_load_dwordx4 v4, s[28:31], s77 offen offset:0 sc1 lds
    v_mfma_f32_16x16x32_bf16 v[156:159], v[68:71], a[116:119], v[156:159]
    buffer_load_dwordx4 v4, s[28:31], s77 offen offset:1024 sc1 lds
    v_mfma_f32_16x16x32_bf16 v[164:167], a[116:119], a[116:119], v[164:167]
    buffer_load_dwordx4 v4, s[28:31], s77 offen offset:2048 sc1 lds
    v_mfma_f32_16x16x32_bf16 v[152:155], v[68:71], a[120:123], v[152:155]
    s_waitcnt vmcnt(7)
    ds_read_b128 a[128:131], v20 offset:32768
    v_mfma_f32_16x16x32_bf16 v[160:163], a[120:123], a[120:123], v[160:163]
    ds_read_b128 a[132:135], v20 offset:34816
    v_mfma_f32_16x16x32_bf16 v[156:159], v[68:71], a[124:127], v[156:159]
    ds_read_b128 a[136:139], v21 offset:32768
    v_mfma_f32_16x16x32_bf16 v[164:167], a[124:127], a[124:127], v[164:167]
    ds_read_b128 a[140:143], v21 offset:34816
    s_waitcnt lgkmcnt(0)
    v_mfma_f32_16x16x32_bf16 v[152:155], v[68:71], a[128:131], v[152:155]
    s_mul_i32 s77, s66, 3072
    s_add_u32 s77, s77, s75
    s_add_u32 m0, s78, 12288
    v_mfma_f32_16x16x32_bf16 v[160:163], a[128:131], a[128:131], v[160:163]
    buffer_load_dwordx4 v4, s[28:31], s77 offen offset:0 sc1 lds
    v_mfma_f32_16x16x32_bf16 v[156:159], v[68:71], a[132:135], v[156:159]
    buffer_load_dwordx4 v4, s[28:31], s77 offen offset:1024 sc1 lds
    v_mfma_f32_16x16x32_bf16 v[164:167], a[132:135], a[132:135], v[164:167]
    buffer_load_dwordx4 v4, s[28:31], s77 offen offset:2048 sc1 lds
    v_mfma_f32_16x16x32_bf16 v[152:155], v[68:71], a[136:139], v[152:155]
    s_waitcnt vmcnt(6)
    ds_read_b128 a[144:147], v26 offset:0
    v_mfma_f32_16x16x32_bf16 v[160:163], a[136:139], a[136:139], v[160:163]
    ds_read_b128 a[148:151], v26 offset:2048
    v_mfma_f32_16x16x32_bf16 v[156:159], v[68:71], a[140:143], v[156:159]
    ds_read_b128 a[152:155], v27 offset:0
    v_mfma_f32_16x16x32_bf16 v[164:167], a[140:143], a[140:143], v[164:167]
    ds_read_b128 a[156:159], v27 offset:2048
    s_waitcnt lgkmcnt(0)
    v_mfma_f32_16x16x32_bf16 v[152:155], v[68:71], a[144:147], v[152:155]
    s_mul_i32 s77, s69, 3072
    s_add_u32 s77, s77, s75
    s_add_u32 m0, s78, 24576
    v_mfma_f32_16x16x32_bf16 v[160:163], a[144:147], a[144:147], v[160:163]
    buffer_load_dwordx4 v4, s[28:31], s77 offen offset:0 sc1 lds
    v_mfma_f32_16x16x32_bf16 v[156:159], v[68:71], a[148:151], v[156:159]
    buffer_load_dwordx4 v4, s[28:31], s77 offen offset:1024 sc1 lds
    v_mfma_f32_16x16x32_bf16 v[164:167], a[148:151], a[148:151], v[164:167]
    buffer_load_dwordx4 v4, s[28:31], s77 offen offset:2048 sc1 lds
    v_mfma_f32_16x16x32_bf16 v[152:155], v[68:71], a[152:155], v[152:155]
    v_mfma_f32_16x16x32_bf16 v[160:163], a[152:155], a[152:155], v[160:163]
    v_mfma_f32_16x16x32_bf16 v[156:159], v[68:71], a[156:159], v[156:159]
    v_mfma_f32_16x16x32_bf16 v[164:167], a[156:159], a[156:159], v[164:167]
    buffer_store_dwordx4 v[180:183], v4, s[28:31], s70 offen sc1
    s_mov_b64 exec, 0x7ff
    global_load_dword v50, v32, s[36:37] offset:128 sc1
    s_mov_b64 exec, -1
    buffer_store_dwordx4 v[64:67], v4, s[28:31], s88 offen sc1
    s_mov_b64 exec, 0xff
    buffer_store_dwordx4 v[232:235], v4, s[28:31], s89 offen sc1
    s_mov_b64 exec, -1
    global_load_dwordx2 a[252:253], v16, s[32:33]
    global_load_ushort a254, v17, s[34:35]
    v_mul_f32 v240, s48, v152
    v_cndmask_b32 v160, v160, v161, s[60:61]
    v_cndmask_b32 v160, v160, v162, s[62:63]
    v_cndmask_b32 v160, v160, v163, s[82:83]
    v_mul_f32 v161, v240, v240
    v_fma_f32 v160, v160, s48, -v161
    v_max_f32 v160, 0, v160
    v_add_f32 v160, s49, v160
    v_rsq_f32 v160, v160
    s_nop 0
    ds_write_b32 v33, v160 offset:0
    v_mul_f32 v241, s48, v156
    v_cndmask_b32 v164, v164, v165, s[60:61]
    v_cndmask_b32 v164, v164, v166, s[62:63]
    v_cndmask_b32 v164, v164, v167, s[82:83]
    v_mul_f32 v165, v241, v241
    v_fma_f32 v164, v164, s48, -v165
    v_max_f32 v164, 0, v164
    v_add_f32 v164, s49, v164
    v_rsq_f32 v164, v164
    s_nop 0
    ds_write_b32 v33, v164 offset:64
    ds_read_b128 v[192:195], v34 offset:0
    ds_read_b32 v246, v35 offset:0
    ds_read_b128 v[196:199], v34 offset:64
    ds_read_b32 v248, v35 offset:64
    v_cvt_pk_bf16_f32 v243, -v240, 0
    v_lshlrev_b32 v7, 16, v243
    v_sub_f32 v8, -v240, v7
    v_cvt_pk_bf16_f32 v242, v7, v8
    v_cvt_pk_bf16_f32 v245, -v241, 0
    v_lshlrev_b32 v7, 16, v245
    v_sub_f32 v8, -v241, v7
    v_cvt_pk_bf16_f32 v244, v7, v8
    s_waitcnt lgkmcnt(0)
    v_mul_f32 v200, s51, v192
    v_mul_f32 v201, s51, v193
    v_mul_f32 v202, s51, v194
    v_mul_f32 v203, s51, v195
    v_mul_f32 v204, s51, v196
    v_mul_f32 v205, s51, v197
    v_mul_f32 v206, s51, v198
    v_mul_f32 v207, s51, v199
    v_mul_f32 v250, s51, v246
    v_mul_f32 v252, s51, v248
    s_waitcnt vmcnt(12)
    s_barrier
    ds_read_b128 v[72:75], v4 offset:0
    ds_read_b128 v[76:79], v4 offset:1024
    ds_read_b128 v[80:83], v4 offset:2048
    s_waitcnt lgkmcnt(1)
    v_mfma_f32_16x16x32_bf16 v[104:107], a[0:3], v[72:75], 0
    ds_read_b128 v[88:91], v4 offset:3072
    v_cmp_gt_u32 s[98:99], 8, v3
    v_and_b32 v9, 4, v3
    v_cmp_ne_u32 s[100:101], 0, v9
    v_and_b32 v8, 7, v1
    v_lshlrev_b32 v8, 4, v8
    v_lshrrev_b32 v7, 3, v0
    s_and_b32 s46, s2, 63
    s_mul_i32 s46, s46, 98304
    s_lshr_b32 s47, s2, 6
    s_lshl_b32 s47, s47, 10
    s_add_u32 s46, s46, s47
    v_mfma_f32_16x16x32_bf16 v[108:111], a[4:7], v[72:75], 0
    ds_read_b128 v[92:95], v4 offset:4096
    s_cmp_lt_u32 s2, 192
    s_cselect_b32 s47, 0, 0x2000000
    v_mfma_f32_16x16x32_bf16 v[112:115], a[0:3], v[76:79], 0
    buffer_load_dwordx4 v[208:211], v29, s[28:31], 0 offen offset:0 sc1
    v_mfma_f32_16x16x32_bf16 v[116:119], a[4:7], v[76:79], 0
    ds_read_b128 v[96:99], v4 offset:5120
    s_waitcnt lgkmcnt(3)
    v_mfma_f32_16x16x32_bf16 v[120:123], a[0:3], v[80:83], 0
    s_add_u32 s46, s46, s47
    v_mul_u32_u24 v10, 3072, v7
    v_add3_u32 v12, v10, v8, s46
    s_lshl_b32 s64, s2, 12
    s_add_u32 s64, s64, s53
    v_mfma_f32_16x16x32_bf16 v[124:127], a[4:7], v[80:83], 0
    buffer_load_dwordx4 v[212:215], v29, s[28:31], 0 offen offset:1024 sc1
    s_waitcnt lgkmcnt(1)
    v_mfma_f32_16x16x32_bf16 v[104:107], a[8:11], v[88:91], v[104:107]
    ds_read_b128 v[72:75], v4 offset:6144
    s_add_u32 s64, s64, s47
    v_mfma_f32_16x16x32_bf16 v[108:111], a[12:15], v[88:91], v[108:111]
    ds_read_b128 v[76:79], v4 offset:7168
    s_add_u32 s64, s64, 11534336
    v_mfma_f32_16x16x32_bf16 v[112:115], a[8:11], v[92:95], v[112:115]
    buffer_load_dwordx4 v[216:219], v29, s[28:31], 0 offen offset:2048 sc1
    v_mfma_f32_16x16x32_bf16 v[116:119], a[12:15], v[92:95], v[116:119]
    ds_read_b128 v[80:83], v4 offset:8192
    s_waitcnt lgkmcnt(3)
    v_mfma_f32_16x16x32_bf16 v[120:123], a[8:11], v[96:99], v[120:123]
    s_lshr_b32 s67, s2, 4
    s_lshl_b32 s67, s67, 7
    s_add_u32 s67, s67, s47
    v_mfma_f32_16x16x32_bf16 v[124:127], a[12:15], v[96:99], v[124:127]
    buffer_load_dwordx4 v[220:223], v29, s[28:31], 0 offen offset:3072 sc1
    s_waitcnt lgkmcnt(1)
    v_mfma_f32_16x16x32_bf16 v[104:107], a[16:19], v[72:75], v[104:107]
    ds_read_b128 v[88:91], v4 offset:9216
    s_sub_u32 s65, s2, 64
    v_mfma_f32_16x16x32_bf16 v[108:111], a[20:23], v[72:75], v[108:111]
    ds_read_b128 v[92:95], v4 offset:10240
    s_and_b32 s65, s65, 255
    v_mfma_f32_16x16x32_bf16 v[112:115], a[16:19], v[76:79], v[112:115]
    buffer_load_dwordx4 v[224:227], v52, s[28:31], 0 offen offset:0 sc1
    v_mfma_f32_16x16x32_bf16 v[116:119], a[20:23], v[76:79], v[116:119]
    ds_read_b128 v[96:99], v4 offset:11264
    s_waitcnt lgkmcnt(3)
    v_mfma_f32_16x16x32_bf16 v[120:123], a[16:19], v[80:83], v[120:123]
    s_mul_i32 s77, s55, 3072
    s_add_u32 s77, s77, s75
    s_add_u32 m0, s78, 36864
    v_mfma_f32_16x16x32_bf16 v[124:127], a[20:23], v[80:83], v[124:127]
    s_waitcnt vmcnt(14)
    s_barrier
    buffer_load_dwordx4 v4, s[28:31], s77 offen offset:0 sc1 lds
    s_waitcnt lgkmcnt(1)
    v_mfma_f32_16x16x32_bf16 v[104:107], a[24:27], v[88:91], v[104:107]
    ds_read_b128 v[72:75], v4 offset:12288
    s_mul_i32 s47, s65, 171
    v_mfma_f32_16x16x32_bf16 v[108:111], a[28:31], v[88:91], v[108:111]
    ds_read_b128 v[76:79], v4 offset:13312
    s_lshr_b32 s47, s47, 13
    v_mfma_f32_16x16x32_bf16 v[112:115], a[24:27], v[92:95], v[112:115]
    buffer_load_dwordx4 v4, s[28:31], s77 offen offset:1024 sc1 lds
    v_mfma_f32_16x16x32_bf16 v[116:119], a[28:31], v[92:95], v[116:119]
    ds_read_b128 v[80:83], v4 offset:14336
    s_waitcnt lgkmcnt(3)
    v_mfma_f32_16x16x32_bf16 v[120:123], a[24:27], v[96:99], v[120:123]
    s_mul_i32 s46, s47, -6290432
    s_lshl_b32 s47, s65, 17
    s_add_u32 s46, s46, s47
    v_mfma_f32_16x16x32_bf16 v[124:127], a[28:31], v[96:99], v[124:127]
    buffer_load_dwordx4 v4, s[28:31], s77 offen offset:2048 sc1 lds
    s_mul_i32 s77, s54, 3072
    s_waitcnt lgkmcnt(1)
    v_mfma_f32_16x16x32_bf16 v[104:107], a[32:35], v[72:75], v[104:107]
    ds_read_b128 v[88:91], v4 offset:15360
    s_add_u32 s77, s77, s75
    v_mfma_f32_16x16x32_bf16 v[108:111], a[36:39], v[72:75], v[108:111]
    ds_read_b128 v[92:95], v4 offset:16384
    s_add_u32 m0, s78, 49152
    v_mfma_f32_16x16x32_bf16 v[112:115], a[32:35], v[76:79], v[112:115]
    buffer_load_dwordx4 v4, s[28:31], s77 offen offset:0 sc1 lds
    v_mfma_f32_16x16x32_bf16 v[116:119], a[36:39], v[76:79], v[116:119]
    ds_read_b128 v[96:99], v4 offset:17408
    s_waitcnt lgkmcnt(3)
    v_mfma_f32_16x16x32_bf16 v[120:123], a[32:35], v[80:83], v[120:123]
    s_cmp_ge_u32 s2, 64
    s_cselect_b32 s47, 0, 0x2000000
    s_add_u32 s46, s46, s47
    v_mfma_f32_16x16x32_bf16 v[124:127], a[36:39], v[80:83], v[124:127]
    buffer_load_dwordx4 v4, s[28:31], s77 offen offset:1024 sc1 lds
    s_waitcnt lgkmcnt(1)
    v_mfma_f32_16x16x32_bf16 v[104:107], a[40:43], v[88:91], v[104:107]
    ds_read_b128 v[72:75], v4 offset:18432
    v_lshlrev_b32 v10, 12, v7
    v_mfma_f32_16x16x32_bf16 v[108:111], a[44:47], v[88:91], v[108:111]
    ds_read_b128 v[76:79], v4 offset:19456
    v_add3_u32 v13, v10, v8, s46
    v_mfma_f32_16x16x32_bf16 v[112:115], a[40:43], v[92:95], v[112:115]
    buffer_load_dwordx4 v4, s[28:31], s77 offen offset:2048 sc1 lds
    s_add_u32 s75, s75, 61440
    s_mul_i32 s78, s76, 2048
    v_mfma_f32_16x16x32_bf16 v[116:119], a[44:47], v[92:95], v[116:119]
    ds_read_b128 v[80:83], v4 offset:20480
    s_waitcnt lgkmcnt(3)
    v_mfma_f32_16x16x32_bf16 v[120:123], a[40:43], v[96:99], v[120:123]
    s_mul_i32 s77, s56, 2048
    s_add_u32 s77, s77, s75
    s_add_u32 m0, s78, 61440
    v_mfma_f32_16x16x32_bf16 v[124:127], a[44:47], v[96:99], v[124:127]
    buffer_load_dwordx4 v4, s[28:31], s77 offen offset:0 sc1 lds
    s_waitcnt lgkmcnt(1)
    v_mfma_f32_16x16x32_bf16 v[104:107], a[48:51], v[72:75], v[104:107]
    ds_read_b128 v[88:91], v4 offset:21504
    s_lshl_b32 s65, s65, 12
    v_mfma_f32_16x16x32_bf16 v[108:111], a[52:55], v[72:75], v[108:111]
    ds_read_b128 v[92:95], v4 offset:22528
    s_add_u32 s65, s65, s53
    v_mfma_f32_16x16x32_bf16 v[112:115], a[48:51], v[76:79], v[112:115]
    buffer_load_dwordx4 v4, s[28:31], s77 offen offset:1024 sc1 lds
    v_mfma_f32_16x16x32_bf16 v[116:119], a[52:55], v[76:79], v[116:119]
    ds_read_b128 v[96:99], v4 offset:23552
    s_waitcnt lgkmcnt(3)
    v_mfma_f32_16x16x32_bf16 v[120:123], a[48:51], v[80:83], v[120:123]
    s_waitcnt vmcnt(17)
    v_cmp_ne_u32 vcc, 1, v50
    s_mov_b32 s57, 0
    s_and_b32 vcc_lo, vcc_lo, 0x7ff
    s_cbranch_scc1 L_gospin_7
L_go_6:
    v_mfma_f32_16x16x32_bf16 v[124:127], a[52:55], v[80:83], v[124:127]
    s_barrier
    s_waitcnt lgkmcnt(1)
    v_mfma_f32_16x16x32_bf16 v[104:107], a[56:59], v[88:91], v[104:107]
    ds_read_b128 v[72:75], v4 offset:24576
    s_add_u32 s65, s65, s47
    v_mfma_f32_16x16x32_bf16 v[108:111], a[60:63], v[88:91], v[108:111]
    ds_read_b128 v[76:79], v4 offset:25600
    s_add_u32 s65, s65, 12845056
    v_mfma_f32_16x16x32_bf16 v[112:115], a[56:59], v[92:95], v[112:115]
    s_mov_b64 exec, 1
    buffer_atomic_add v5, off, s[28:31], s72 sc1
    s_mov_b64 exec, -1
    v_mfma_f32_16x16x32_bf16 v[116:119], a[60:63], v[92:95], v[116:119]
    ds_read_b128 v[80:83], v4 offset:26624
    s_waitcnt lgkmcnt(3)
    v_mfma_f32_16x16x32_bf16 v[120:123], a[56:59], v[96:99], v[120:123]
    s_mul_i32 s77, s66, 2048
    s_add_u32 s77, s77, s75
    s_add_u32 m0, s78, 69632
    v_mfma_f32_16x16x32_bf16 v[124:127], a[60:63], v[96:99], v[124:127]
    buffer_load_dwordx4 v4, s[28:31], s77 offen offset:0 sc1 lds
    s_waitcnt lgkmcnt(1)
    v_mfma_f32_16x16x32_bf16 v[104:107], a[64:67], v[72:75], v[104:107]
    ds_read_b128 v[88:91], v4 offset:27648
    s_waitcnt vmcnt(10)
    v_add_f32 v208, v208, v212
    v_add_f32 v209, v209, v213
    v_add_f32 v210, v210, v214
    v_add_f32 v208, v208, v216
    v_add_f32 v209, v209, v217
    v_add_f32 v210, v210, v218
    v_add_f32 v208, v208, v220
    v_add_f32 v209, v209, v221
    v_mfma_f32_16x16x32_bf16 v[108:111], a[68:71], v[72:75], v[108:111]
    ds_read_b128 v[92:95], v4 offset:28672
    v_add_f32 v210, v210, v222
    v_mfma_f32_16x16x32_bf16 v[112:115], a[64:67], v[76:79], v[112:115]
    buffer_load_dwordx4 v4, s[28:31], s77 offen offset:1024 sc1 lds
    v_mfma_f32_16x16x32_bf16 v[116:119], a[68:71], v[76:79], v[116:119]
    ds_read_b128 v[96:99], v4 offset:29696
    s_waitcnt lgkmcnt(3)
    v_mfma_f32_16x16x32_bf16 v[120:123], a[64:67], v[80:83], v[120:123]
    s_mul_i32 s77, s69, 2048
    s_add_u32 s77, s77, s75
    s_add_u32 m0, s78, 77824
    v_mfma_f32_16x16x32_bf16 v[124:127], a[68:71], v[80:83], v[124:127]
    buffer_load_dwordx4 v4, s[28:31], s77 offen offset:0 sc1 lds
    s_waitcnt lgkmcnt(1)
    v_mfma_f32_16x16x32_bf16 v[104:107], a[72:75], v[88:91], v[104:107]
    ds_read_b128 v[72:75], v4 offset:30720
    v_add_f32 v208, v208, v224
    v_mfma_f32_16x16x32_bf16 v[108:111], a[76:79], v[88:91], v[108:111]
    ds_read_b128 v[76:79], v4 offset:31744
    v_add_f32 v209, v209, v225
    v_mfma_f32_16x16x32_bf16 v[112:115], a[72:75], v[92:95], v[112:115]
    buffer_load_dwordx4 v4, s[28:31], s77 offen offset:1024 sc1 lds
    v_mfma_f32_16x16x32_bf16 v[116:119], a[76:79], v[92:95], v[116:119]
    ds_read_b128 v[80:83], v4 offset:32768
    s_waitcnt lgkmcnt(3)
    v_mfma_f32_16x16x32_bf16 v[120:123], a[72:75], v[96:99], v[120:123]
    s_mul_i32 s77, s55, 2048
    s_add_u32 s77, s77, s75
    s_add_u32 m0, s78, 86016
    v_mfma_f32_16x16x32_bf16 v[124:127], a[76:79], v[96:99], v[124:127]
    buffer_load_dwordx4 v4, s[28:31], s77 offen offset:0 sc1 lds
    s_waitcnt lgkmcnt(1)
    v_mfma_f32_16x16x32_bf16 v[104:107], a[80:83], v[72:75], v[104:107]
    ds_read_b128 v[88:91], v4 offset:33792
    v_add_f32 v210, v210, v226
    v_mfma_f32_16x16x32_bf16 v[108:111], a[84:87], v[72:75], v[108:111]
    ds_read_b128 v[92:95], v4 offset:34816
    ds_write_b128 v55, v[208:211]
    v_mfma_f32_16x16x32_bf16 v[112:115], a[80:83], v[76:79], v[112:115]
    buffer_load_dwordx4 v4, s[28:31], s77 offen offset:1024 sc1 lds
    v_mfma_f32_16x16x32_bf16 v[116:119], a[84:87], v[76:79], v[116:119]
    ds_read_b128 v[96:99], v4 offset:35840
    s_waitcnt lgkmcnt(4)
    v_mfma_f32_16x16x32_bf16 v[120:123], a[80:83], v[80:83], v[120:123]
    s_mul_i32 s77, s54, 2048
    s_add_u32 s77, s77, s75
    s_add_u32 m0, s78, 94208
    v_mfma_f32_16x16x32_bf16 v[124:127], a[84:87], v[80:83], v[124:127]
    s_waitcnt lgkmcnt(1)
    s_waitcnt vmcnt(12)
    s_barrier
    buffer_load_dwordx4 v4, s[28:31], s77 offen offset:0 sc1 lds
    v_mfma_f32_16x16x32_bf16 v[104:107], a[88:91], v[88:91], v[104:107]
    ds_read_b128 v[72:75], v4 offset:36864
    ds_read_b128 v[156:159], v56 offset:1024
    v_mfma_f32_16x16x32_bf16 v[108:111], a[92:95], v[88:91], v[108:111]
    ds_read_b128 v[76:79], v4 offset:37888
    ds_read_b128 v[160:163], v56 offset:2048
    v_mfma_f32_16x16x32_bf16 v[112:115], a[88:91], v[92:95], v[112:115]
    buffer_load_dwordx4 v4, s[28:31], s77 offen offset:1024 sc1 lds
    s_add_u32 s75, s75, 40960
    s_mul_i32 s78, s76, 2560
    v_mfma_f32_16x16x32_bf16 v[116:119], a[92:95], v[92:95], v[116:119]
    ds_read_b128 v[80:83], v4 offset:38912
    s_waitcnt lgkmcnt(5)
    v_mfma_f32_16x16x32_bf16 v[120:123], a[88:91], v[96:99], v[120:123]
    s_mul_i32 s77, s56, 2560
    s_add_u32 s77, s77, s75
    s_add_u32 m0, s78, 112128
    v_mfma_f32_16x16x32_bf16 v[124:127], a[92:95], v[96:99], v[124:127]
    buffer_load_dwordx4 v4, s[28:31], s77 offen offset:0 sc1 lds
    s_waitcnt lgkmcnt(2)
    v_mfma_f32_16x16x32_bf16 v[104:107], a[96:99], v[72:75], v[104:107]
    ds_read_b128 v[88:91], v4 offset:39936
    ds_read_b128 v[152:155], v56 offset:0
    v_mfma_f32_16x16x32_bf16 v[108:111], a[100:103], v[72:75], v[108:111]
    ds_read_b128 v[92:95], v4 offset:40960
    v_mfma_f32_16x16x32_bf16 v[112:115], a[96:99], v[76:79], v[112:115]
    buffer_load_dwordx4 v4, s[28:31], s77 offen offset:1024 sc1 lds
    v_mfma_f32_16x16x32_bf16 v[116:119], a[100:103], v[76:79], v[116:119]
    ds_read_b128 v[96:99], v4 offset:41984
    s_waitcnt lgkmcnt(4)
    v_mfma_f32_16x16x32_bf16 v[120:123], a[96:99], v[80:83], v[120:123]
    s_waitcnt lgkmcnt(2)
    v_cndmask_b32 v158, v162, v158, s[98:99]
    v_cvt_pk_bf16_f32 v164, v156, v156
    v_mfma_f32_16x16x32_bf16 v[124:127], a[100:103], v[80:83], v[124:127]
    s_mov_b32 exec_hi, 0
    buffer_load_dwordx4 v4, s[28:31], s77 offen offset:2048 sc1 lds
    s_mov_b32 exec_hi, -1
    s_mul_i32 s77, s66, 2560
    s_waitcnt lgkmcnt(1)
    v_mfma_f32_16x16x32_bf16 v[104:107], a[104:107], v[88:91], v[104:107]
    ds_read_b128 v[72:75], v4 offset:43008
    s_add_u32 s77, s77, s75
    v_mfma_f32_16x16x32_bf16 v[108:111], a[108:111], v[88:91], v[108:111]
    ds_read_b128 v[76:79], v4 offset:44032
    s_add_u32 m0, s78, 122368
    v_mfma_f32_16x16x32_bf16 v[112:115], a[104:107], v[92:95], v[112:115]
    buffer_load_dwordx4 v4, s[28:31], s77 offen offset:0 sc1 lds
    v_mfma_f32_16x16x32_bf16 v[116:119], a[108:111], v[92:95], v[116:119]
    ds_read_b128 v[80:83], v4 offset:45056
    s_waitcnt lgkmcnt(3)
    v_mfma_f32_16x16x32_bf16 v[120:123], a[104:107], v[96:99], v[120:123]
    v_lshlrev_b32 v165, 16, v164
    v_sub_f32 v165, v156, v165
    v_mfma_f32_16x16x32_bf16 v[124:127], a[108:111], v[96:99], v[124:127]
    buffer_load_dwordx4 v4, s[28:31], s77 offen offset:1024 sc1 lds
    s_waitcnt lgkmcnt(1)
    v_mfma_f32_16x16x32_bf16 v[104:107], a[112:115], v[72:75], v[104:107]
    ds_read_b128 v[88:91], v4 offset:46080
    v_cvt_pk_bf16_f32 v165, v165, 0
    v_mfma_f32_16x16x32_bf16 v[108:111], a[116:119], v[72:75], v[108:111]
    ds_read_b128 v[92:95], v4 offset:47104
    v_cvt_pk_bf16_f32 v166, v157, v157
    v_mfma_f32_16x16x32_bf16 v[112:115], a[112:115], v[76:79], v[112:115]
    s_mov_b32 exec_hi, 0
    buffer_load_dwordx4 v4, s[28:31], s77 offen offset:2048 sc1 lds
    s_mov_b32 exec_hi, -1
    v_mfma_f32_16x16x32_bf16 v[116:119], a[116:119], v[76:79], v[116:119]
    ds_read_b128 v[96:99], v4 offset:48128
    s_waitcnt lgkmcnt(3)
    v_mfma_f32_16x16x32_bf16 v[120:123], a[112:115], v[80:83], v[120:123]
    s_mul_i32 s77, s69, 2560
    s_add_u32 s77, s77, s75
    s_add_u32 m0, s78, 132608
    v_mfma_f32_16x16x32_bf16 v[124:127], a[116:119], v[80:83], v[124:127]
    s_waitcnt vmcnt(17)
    s_barrier
    buffer_load_dwordx4 v4, s[28:31], s77 offen offset:0 sc1 lds
    s_waitcnt lgkmcnt(1)
    v_mfma_f32_16x16x32_bf16 v[104:107], a[120:123], v[88:91], v[104:107]
    ds_read_b128 v[72:75], v4 offset:49152
    v_lshlrev_b32 v167, 16, v166
    v_mfma_f32_16x16x32_bf16 v[108:111], a[124:127], v[88:91], v[108:111]
    ds_read_b128 v[76:79], v4 offset:50176
    v_sub_f32 v167, v157, v167
    v_mfma_f32_16x16x32_bf16 v[112:115], a[120:123], v[92:95], v[112:115]
    buffer_load_dwordx4 v4, s[28:31], s77 offen offset:1024 sc1 lds
    v_mfma_f32_16x16x32_bf16 v[116:119], a[124:127], v[92:95], v[116:119]
    ds_read_b128 v[80:83], v4 offset:51200
    s_waitcnt lgkmcnt(3)
    v_mfma_f32_16x16x32_bf16 v[120:123], a[120:123], v[96:99], v[120:123]
    v_cvt_pk_bf16_f32 v167, v167, 0
    v_cvt_pk_bf16_f32 v168, v158, v158
    v_mfma_f32_16x16x32_bf16 v[124:127], a[124:127], v[96:99], v[124:127]
    s_mov_b32 exec_hi, 0
    buffer_load_dwordx4 v4, s[28:31], s77 offen offset:2048 sc1 lds
    s_mov_b32 exec_hi, -1
    s_mul_i32 s77, s55, 2560
    s_waitcnt lgkmcnt(1)
    v_mfma_f32_16x16x32_bf16 v[104:107], a[128:131], v[72:75], v[104:107]
    ds_read_b128 v[88:91], v4 offset:52224
    s_add_u32 s77, s77, s75
    v_mfma_f32_16x16x32_bf16 v[108:111], a[132:135], v[72:75], v[108:111]
    ds_read_b128 v[92:95], v4 offset:53248
    s_add_u32 m0, s78, 142848
    v_mfma_f32_16x16x32_bf16 v[112:115], a[128:131], v[76:79], v[112:115]
    buffer_load_dwordx4 v4, s[28:31], s77 offen offset:0 sc1 lds
    v_mfma_f32_16x16x32_bf16 v[116:119], a[132:135], v[76:79], v[116:119]
    ds_read_b128 v[96:99], v4 offset:54272
    s_waitcnt lgkmcnt(3)
    v_mfma_f32_16x16x32_bf16 v[120:123], a[128:131], v[80:83], v[120:123]
    v_lshlrev_b32 v169, 16, v168
    v_sub_f32 v169, v158, v169
    v_mfma_f32_16x16x32_bf16 v[124:127], a[132:135], v[80:83], v[124:127]
    buffer_load_dwordx4 v4, s[28:31], s77 offen offset:1024 sc1 lds
    s_waitcnt lgkmcnt(1)
    v_mfma_f32_16x16x32_bf16 v[104:107], a[136:139], v[88:91], v[104:107]
    ds_read_b128 v[72:75], v4 offset:55296
    v_cvt_pk_bf16_f32 v169, v169, 0
    v_mfma_f32_16x16x32_bf16 v[108:111], a[140:143], v[88:91], v[108:111]
    ds_read_b128 v[76:79], v4 offset:56320
    v_mfma_f32_16x16x32_bf16 v[112:115], a[136:139], v[92:95], v[112:115]
    s_mov_b32 exec_hi, 0
    buffer_load_dwordx4 v4, s[28:31], s77 offen offset:2048 sc1 lds
    s_mov_b32 exec_hi, -1
    v_mfma_f32_16x16x32_bf16 v[116:119], a[140:143], v[92:95], v[116:119]
    ds_read_b128 v[80:83], v4 offset:57344
    s_waitcnt lgkmcnt(3)
    v_mfma_f32_16x16x32_bf16 v[120:123], a[136:139], v[96:99], v[120:123]
    s_mul_i32 s77, s54, 2560
    s_add_u32 s77, s77, s75
    s_add_u32 m0, s78, 153088
    v_mfma_f32_16x16x32_bf16 v[124:127], a[140:143], v[96:99], v[124:127]
    buffer_load_dwordx4 v4, s[28:31], s77 offen offset:0 sc1 lds
    v_cvt_pk_bf16_f32 v170, v160, v160
    v_lshlrev_b32 v171, 16, v170
    v_sub_f32 v171, v160, v171
    v_cvt_pk_bf16_f32 v171, v171, 0
    v_mfma_f32_16x16x16_bf16 v[104:107], v[242:243], v[164:165], v[104:107]
    v_cvt_pk_bf16_f32 v172, v161, v161
    v_lshlrev_b32 v173, 16, v172
    v_mfma_f32_16x16x16_bf16 v[108:111], v[244:245], v[164:165], v[108:111]
    v_sub_f32 v173, v161, v173
    v_cvt_pk_bf16_f32 v173, v173, 0
    v_mfma_f32_16x16x16_bf16 v[112:115], v[242:243], v[166:167], v[112:115]
    buffer_load_dwordx4 v4, s[28:31], s77 offen offset:1024 sc1 lds
    v_mfma_f32_16x16x16_bf16 v[116:119], v[244:245], v[166:167], v[116:119]
    v_cvt_pk_bf16_f32 v184, v152, v152
    v_lshlrev_b32 v185, 16, v184
    v_mfma_f32_16x16x16_bf16 v[120:123], v[242:243], v[168:169], v[120:123]
    v_sub_f32 v185, v152, v185
    v_cvt_pk_bf16_f32 v185, v185, 0
    v_mfma_f32_16x16x16_bf16 v[124:127], v[244:245], v[168:169], v[124:127]
    s_mov_b32 exec_hi, 0
    buffer_load_dwordx4 v4, s[28:31], s77 offen offset:2048 sc1 lds
    s_mov_b32 exec_hi, -1
    s_waitcnt lgkmcnt(1)
    v_mfma_f32_16x16x32_bf16 v[104:107], a[144:147], v[72:75], v[104:107]
    ds_read_b128 v[88:91], v4 offset:58368
    v_cvt_pk_bf16_f32 v186, v153, v153
    v_mfma_f32_16x16x32_bf16 v[108:111], a[148:151], v[72:75], v[108:111]
    ds_read_b128 v[92:95], v4 offset:59392
    v_lshlrev_b32 v187, 16, v186
    v_mfma_f32_16x16x32_bf16 v[112:115], a[144:147], v[76:79], v[112:115]
    v_mov_b32 v51, 0
    s_mov_b64 exec, 1
    buffer_atomic_add v51, v6, s[28:31], s74 offen sc0 sc1
    s_mov_b64 exec, -1
    v_mfma_f32_16x16x32_bf16 v[116:119], a[148:151], v[76:79], v[116:119]
    ds_read_b128 v[96:99], v4 offset:60416
    s_waitcnt lgkmcnt(3)
    v_mfma_f32_16x16x32_bf16 v[120:123], a[144:147], v[80:83], v[120:123]
    v_sub_f32 v187, v153, v187
    v_cvt_pk_bf16_f32 v187, v187, 0
    v_mfma_f32_16x16x32_bf16 v[124:127], a[148:151], v[80:83], v[124:127]
    s_waitcnt vmcnt(16)
    s_barrier
    buffer_load_dwordx4 v[84:87], v12, s[12:15], 0 offen offset:384
    s_waitcnt lgkmcnt(1)
    v_mfma_f32_16x16x32_bf16 v[104:107], a[152:155], v[88:91], v[104:107]
    ds_read_b128 v[72:75], v28 offset:0
    v_cvt_pk_bf16_f32 v188, v154, v154
    v_mfma_f32_16x16x32_bf16 v[108:111], a[156:159], v[88:91], v[108:111]
    ds_read_b128 v[76:79], v28 offset:1024
    v_lshlrev_b32 v189, 16, v188
    v_mfma_f32_16x16x32_bf16 v[112:115], a[152:155], v[92:95], v[112:115]
    buffer_load_dwordx4 v[100:103], v13, s[16:19], 0 offen offset:384
    v_mfma_f32_16x16x32_bf16 v[116:119], a[156:159], v[92:95], v[116:119]
    s_bitcmp1_b32 s2, 0
    s_cselect_b32 s97, 3145728, 0
    s_waitcnt lgkmcnt(2)
    v_mfma_f32_16x16x32_bf16 v[120:123], a[152:155], v[96:99], v[120:123]
    v_sub_f32 v189, v154, v189
    v_cvt_pk_bf16_f32 v189, v189, 0
    v_mfma_f32_16x16x32_bf16 v[124:127], a[156:159], v[96:99], v[124:127]
    buffer_load_dword v254, v30, s[12:15], s97 offen
    v_mfma_f32_16x16x16_bf16 v[128:131], v[242:243], v[170:171], 0
    v_mfma_f32_16x16x16_bf16 v[132:135], v[244:245], v[170:171], 0
    v_mul_f32 v232, v104, v200
    v_mul_f32 v233, v105, v201
    v_mfma_f32_16x16x16_bf16 v[136:139], v[242:243], v[172:173], 0
    v_mul_f32 v234, v106, v202
    v_mul_f32 v235, v107, v203
    v_mfma_f32_16x16x16_bf16 v[140:143], v[244:245], v[172:173], 0
    v_exp_f32_e64 v232, v232 clamp
    s_waitcnt lgkmcnt(1)
    v_mfma_f32_16x16x32_bf16 v[128:131], a[0:3], v[72:75], v[128:131]
    ds_read_b128 v[88:91], v28 offset:2048
    v_fma_f32 v104, v104, v192, s58
    v_max_f32 v104, s58, v104
    v_mfma_f32_16x16x32_bf16 v[132:135], a[4:7], v[72:75], v[132:135]
    ds_read_b128 v[92:95], v28 offset:3072
    v_exp_f32_e64 v233, v233 clamp
    v_fma_f32 v105, v105, v193, s58
    s_waitcnt lgkmcnt(2)
    v_mfma_f32_16x16x32_bf16 v[136:139], a[0:3], v[76:79], v[136:139]
    v_max_f32 v105, s58, v105
    v_exp_f32_e64 v234, v234 clamp
    v_mfma_f32_16x16x32_bf16 v[140:143], a[4:7], v[76:79], v[140:143]
    s_barrier
    v_fma_f32 v106, v106, v194, s58
    s_waitcnt lgkmcnt(1)
    v_mfma_f32_16x16x32_bf16 v[128:131], a[8:11], v[88:91], v[128:131]
    ds_read_b128 v[72:75], v28 offset:4096
    v_max_f32 v106, s58, v106
    v_exp_f32_e64 v235, v235 clamp
    v_mfma_f32_16x16x32_bf16 v[132:135], a[12:15], v[88:91], v[132:135]
    ds_read_b128 v[76:79], v28 offset:5120
    v_fma_f32 v107, v107, v195, s58
    v_max_f32 v107, s58, v107
    s_waitcnt lgkmcnt(2)
    v_mfma_f32_16x16x32_bf16 v[136:139], a[8:11], v[92:95], v[136:139]
    v_add_f32 v104, v104, v232
    v_add_f32 v105, v105, v233
    v_mfma_f32_16x16x32_bf16 v[140:143], a[12:15], v[92:95], v[140:143]
    v_add_f32 v106, v106, v234
    v_add_f32 v107, v107, v235
    s_waitcnt lgkmcnt(1)
    v_mfma_f32_16x16x32_bf16 v[128:131], a[16:19], v[72:75], v[128:131]
    ds_read_b128 v[88:91], v28 offset:6144
    v_cvt_pk_bf16_f32 v208, v104, v105
    v_mfma_f32_16x16x32_bf16 v[132:135], a[20:23], v[72:75], v[132:135]
    ds_read_b128 v[92:95], v28 offset:7168
    v_cvt_pk_bf16_f32 v209, v106, v107
    v_mul_f32 v232, v108, v204
    s_waitcnt lgkmcnt(2)
    v_mfma_f32_16x16x32_bf16 v[136:139], a[16:19], v[76:79], v[136:139]
    v_mul_f32 v233, v109, v205
    v_mul_f32 v234, v110, v206
    v_mfma_f32_16x16x32_bf16 v[140:143], a[20:23], v[76:79], v[140:143]
    v_mul_f32 v235, v111, v207
    v_exp_f32_e64 v232, v232 clamp
    s_waitcnt lgkmcnt(1)
    v_mfma_f32_16x16x32_bf16 v[128:131], a[24:27], v[88:91], v[128:131]
    ds_read_b128 v[72:75], v28 offset:8192
    v_fma_f32 v108, v108, v196, s58
    v_max_f32 v108, s58, v108
    v_mfma_f32_16x16x32_bf16 v[132:135], a[28:31], v[88:91], v[132:135]
    ds_read_b128 v[76:79], v28 offset:9216
    v_exp_f32_e64 v233, v233 clamp
    s_waitcnt lgkmcnt(2)
    v_mfma_f32_16x16x32_bf16 v[136:139], a[24:27], v[92:95], v[136:139]
    v_fma_f32 v109, v109, v197, s58
    v_max_f32 v109, s58, v109
    v_mfma_f32_16x16x32_bf16 v[140:143], a[28:31], v[92:95], v[140:143]
    v_exp_f32_e64 v234, v234 clamp
    v_fma_f32 v110, v110, v198, s58
    s_waitcnt lgkmcnt(1)
    v_mfma_f32_16x16x32_bf16 v[128:131], a[32:35], v[72:75], v[128:131]
    ds_read_b128 v[88:91], v28 offset:10240
    v_max_f32 v110, s58, v110
    v_exp_f32_e64 v235, v235 clamp
    v_mfma_f32_16x16x32_bf16 v[132:135], a[36:39], v[72:75], v[132:135]
    ds_read_b128 v[92:95], v28 offset:11264
    v_fma_f32 v111, v111, v199, s58
    s_waitcnt lgkmcnt(2)
    v_mfma_f32_16x16x32_bf16 v[136:139], a[32:35], v[76:79], v[136:139]
    v_max_f32 v111, s58, v111
    v_add_f32 v108, v108, v232
    v_mfma_f32_16x16x32_bf16 v[140:143], a[36:39], v[76:79], v[140:143]
    v_add_f32 v109, v109, v233
    v_add_f32 v110, v110, v234
    s_waitcnt lgkmcnt(1)
    v_mfma_f32_16x16x32_bf16 v[128:131], a[40:43], v[88:91], v[128:131]
    ds_read_b128 v[72:75], v28 offset:12288
    v_add_f32 v111, v111, v235
    v_cvt_pk_bf16_f32 v210, v108, v109
    v_mfma_f32_16x16x32_bf16 v[132:135], a[44:47], v[88:91], v[132:135]
    ds_read_b128 v[76:79], v28 offset:13312
    v_cvt_pk_bf16_f32 v211, v110, v111
    s_waitcnt lgkmcnt(2)
    v_mfma_f32_16x16x32_bf16 v[136:139], a[40:43], v[92:95], v[136:139]
    v_mul_f32 v232, v112, v200
    v_mul_f32 v233, v113, v201
    v_mfma_f32_16x16x32_bf16 v[140:143], a[44:47], v[92:95], v[140:143]
    v_mul_f32 v234, v114, v202
    v_mul_f32 v235, v115, v203
    s_waitcnt lgkmcnt(1)
    v_mfma_f32_16x16x32_bf16 v[128:131], a[48:51], v[72:75], v[128:131]
    ds_read_b128 v[88:91], v28 offset:14336
    v_exp_f32_e64 v232, v232 clamp
    v_fma_f32 v112, v112, v192, s58
    v_mfma_f32_16x16x32_bf16 v[132:135], a[52:55], v[72:75], v[132:135]
    ds_read_b128 v[92:95], v28 offset:15360
    v_max_f32 v112, s58, v112
    v_exp_f32_e64 v233, v233 clamp
    s_waitcnt lgkmcnt(2)
    v_mfma_f32_16x16x32_bf16 v[136:139], a[48:51], v[76:79], v[136:139]
    v_fma_f32 v113, v113, v193, s58
    v_max_f32 v113, s58, v113
    v_mfma_f32_16x16x32_bf16 v[140:143], a[52:55], v[76:79], v[140:143]
    v_exp_f32_e64 v234, v234 clamp
    s_waitcnt lgkmcnt(1)
    v_mfma_f32_16x16x32_bf16 v[128:131], a[56:59], v[88:91], v[128:131]
    ds_read_b128 v[72:75], v28 offset:16384
    v_fma_f32 v114, v114, v194, s58
    v_max_f32 v114, s58, v114
    v_mfma_f32_16x16x32_bf16 v[132:135], a[60:63], v[88:91], v[132:135]
    ds_read_b128 v[76:79], v28 offset:17408
    v_exp_f32_e64 v235, v235 clamp
    v_fma_f32 v115, v115, v195, s58
    s_waitcnt lgkmcnt(2)
    v_mfma_f32_16x16x32_bf16 v[136:139], a[56:59], v[92:95], v[136:139]
    v_max_f32 v115, s58, v115
    v_add_f32 v112, v112, v232
    v_mfma_f32_16x16x32_bf16 v[140:143], a[60:63], v[92:95], v[140:143]
    v_add_f32 v113, v113, v233
    s_waitcnt lgkmcnt(1)
    v_mfma_f32_16x16x32_bf16 v[128:131], a[64:67], v[72:75], v[128:131]
    ds_read_b128 v[88:91], v28 offset:18432
    v_add_f32 v114, v114, v234
    v_add_f32 v115, v115, v235
    v_mfma_f32_16x16x32_bf16 v[132:135], a[68:71], v[72:75], v[132:135]
    ds_read_b128 v[92:95], v28 offset:19456
    v_cvt_pk_bf16_f32 v212, v112, v113
    v_cvt_pk_bf16_f32 v213, v114, v115
    s_waitcnt lgkmcnt(2)
    v_mfma_f32_16x16x32_bf16 v[136:139], a[64:67], v[76:79], v[136:139]
    v_mul_f32 v232, v116, v204
    v_mul_f32 v233, v117, v205
    v_mfma_f32_16x16x32_bf16 v[140:143], a[68:71], v[76:79], v[140:143]
    v_mul_f32 v234, v118, v206
    v_mul_f32 v235, v119, v207
    s_waitcnt lgkmcnt(1)
    v_mfma_f32_16x16x32_bf16 v[128:131], a[72:75], v[88:91], v[128:131]
    ds_read_b128 v[72:75], v28 offset:20480
    v_exp_f32_e64 v232, v232 clamp
    v_mfma_f32_16x16x32_bf16 v[132:135], a[76:79], v[88:91], v[132:135]
    ds_read_b128 v[76:79], v28 offset:21504
    v_fma_f32 v116, v116, v196, s58
    v_max_f32 v116, s58, v116
    s_waitcnt lgkmcnt(2)
    v_mfma_f32_16x16x32_bf16 v[136:139], a[72:75], v[92:95], v[136:139]
    v_exp_f32_e64 v233, v233 clamp
    v_fma_f32 v117, v117, v197, s58
    v_mfma_f32_16x16x32_bf16 v[140:143], a[76:79], v[92:95], v[140:143]
    v_max_f32 v117, s58, v117
    v_exp_f32_e64 v234, v234 clamp
    s_waitcnt lgkmcnt(1)
    v_mfma_f32_16x16x32_bf16 v[128:131], a[80:83], v[72:75], v[128:131]
    ds_read_b128 v[88:91], v28 offset:22528
    v_fma_f32 v118, v118, v198, s58
    v_mfma_f32_16x16x32_bf16 v[132:135], a[84:87], v[72:75], v[132:135]
    ds_read_b128 v[92:95], v28 offset:23552
    v_max_f32 v118, s58, v118
    v_exp_f32_e64 v235, v235 clamp
    s_waitcnt lgkmcnt(2)
    v_mfma_f32_16x16x32_bf16 v[136:139], a[80:83], v[76:79], v[136:139]
    v_fma_f32 v119, v119, v199, s58
    v_max_f32 v119, s58, v119
    v_mfma_f32_16x16x32_bf16 v[140:143], a[84:87], v[76:79], v[140:143]
    v_add_f32 v116, v116, v232
    v_add_f32 v117, v117, v233
    s_waitcnt lgkmcnt(1)
    v_mfma_f32_16x16x32_bf16 v[128:131], a[88:91], v[88:91], v[128:131]
    ds_read_b128 v[72:75], v28 offset:24576
    v_add_f32 v118, v118, v234
    v_add_f32 v119, v119, v235
    v_mfma_f32_16x16x32_bf16 v[132:135], a[92:95], v[88:91], v[132:135]
    ds_read_b128 v[76:79], v28 offset:25600
    v_cvt_pk_bf16_f32 v214, v116, v117
    s_waitcnt lgkmcnt(2)
    v_mfma_f32_16x16x32_bf16 v[136:139], a[88:91], v[92:95], v[136:139]
    v_cvt_pk_bf16_f32 v215, v118, v119
    v_mul_f32 v236, v120, v192
    v_mfma_f32_16x16x32_bf16 v[140:143], a[92:95], v[92:95], v[140:143]
    v_mul_f32 v237, v121, v193
    v_mul_f32 v238, v122, v194
    s_waitcnt lgkmcnt(1)
    v_mfma_f32_16x16x32_bf16 v[128:131], a[96:99], v[72:75], v[128:131]
    ds_read_b128 v[88:91], v28 offset:26624
    v_mul_f32 v239, v123, v195
    v_cvt_pk_bf16_f32 v228, v236, v237
    v_mfma_f32_16x16x32_bf16 v[132:135], a[100:103], v[72:75], v[132:135]
    ds_read_b128 v[92:95], v28 offset:27648
    v_cvt_pk_bf16_f32 v229, v238, v239
    s_waitcnt lgkmcnt(2)
    v_mfma_f32_16x16x32_bf16 v[136:139], a[96:99], v[76:79], v[136:139]
    v_cndmask_b32 v228, v228, v68, s[98:99]
    v_cndmask_b32 v229, v229, v68, s[98:99]
    v_mfma_f32_16x16x32_bf16 v[140:143], a[100:103], v[76:79], v[140:143]
    v_mul_f32 v232, v120, v200
    v_mul_f32 v233, v121, v201
    s_waitcnt lgkmcnt(1)
    v_mfma_f32_16x16x32_bf16 v[128:131], a[104:107], v[88:91], v[128:131]
    ds_read_b128 v[72:75], v28 offset:28672
    v_mul_f32 v234, v122, v202
    v_mul_f32 v235, v123, v203
    v_mfma_f32_16x16x32_bf16 v[132:135], a[108:111], v[88:91], v[132:135]
    ds_read_b128 v[76:79], v28 offset:29696
    v_exp_f32_e64 v232, v232 clamp
    v_fma_f32 v120, v120, v192, s58
    s_waitcnt lgkmcnt(2)
    v_mfma_f32_16x16x32_bf16 v[136:139], a[104:107], v[92:95], v[136:139]
    s_waitcnt vmcnt(3)
    v_cmp_gt_u32 vcc, 25, v51
    s_mov_b32 s57, 0
    s_and_b32 vcc_lo, vcc_lo, 1
    s_cbranch_scc1 L_slow_O_8
L_back_O_9:
    v_max_f32 v120, s58, v120
    v_mfma_f32_16x16x32_bf16 v[140:143], a[108:111], v[92:95], v[140:143]
    v_exp_f32_e64 v233, v233 clamp
    v_fma_f32 v121, v121, v193, s58
    s_waitcnt lgkmcnt(1)
    v_mfma_f32_16x16x32_bf16 v[128:131], a[112:115], v[72:75], v[128:131]
    ds_read_b128 v[88:91], v28 offset:30720
    v_max_f32 v121, s58, v121
    v_exp_f32_e64 v234, v234 clamp
    v_mfma_f32_16x16x32_bf16 v[132:135], a[116:119], v[72:75], v[132:135]
    ds_read_b128 v[92:95], v28 offset:31744
    v_fma_f32 v122, v122, v194, s58
    v_max_f32 v122, s58, v122
    s_waitcnt lgkmcnt(2)
    v_mfma_f32_16x16x32_bf16 v[136:139], a[112:115], v[76:79], v[136:139]
    s_waitcnt vmcnt(1)
    buffer_store_dwordx4 v[84:87], v4, s[28:31], s64 offen sc1
    v_exp_f32_e64 v235, v235 clamp
    v_fma_f32 v123, v123, v195, s58
    v_mfma_f32_16x16x32_bf16 v[140:143], a[116:119], v[76:79], v[140:143]
    v_max_f32 v123, s58, v123
    s_waitcnt lgkmcnt(1)
    v_mfma_f32_16x16x32_bf16 v[128:131], a[120:123], v[88:91], v[128:131]
    ds_read_b128 v[72:75], v28 offset:32768
    v_add_f32 v120, v120, v232
    v_add_f32 v121, v121, v233
    v_mfma_f32_16x16x32_bf16 v[132:135], a[124:127], v[88:91], v[132:135]
    ds_read_b128 v[76:79], v28 offset:33792
    v_add_f32 v122, v122, v234
    v_add_f32 v123, v123, v235
    s_waitcnt lgkmcnt(2)
    v_mfma_f32_16x16x32_bf16 v[136:139], a[120:123], v[92:95], v[136:139]
    buffer_store_dwordx4 v[100:103], v4, s[28:31], s65 offen sc1
    v_cvt_pk_bf16_f32 v216, v120, v121
    v_cvt_pk_bf16_f32 v217, v122, v123
    v_mfma_f32_16x16x32_bf16 v[140:143], a[124:127], v[92:95], v[140:143]
    v_mul_f32 v236, v124, v196
    s_waitcnt lgkmcnt(1)
    v_mfma_f32_16x16x32_bf16 v[128:131], a[128:131], v[72:75], v[128:131]
    ds_read_b128 v[88:91], v28 offset:34816
    v_mul_f32 v237, v125, v197
    v_mul_f32 v238, v126, v198
    v_mfma_f32_16x16x32_bf16 v[132:135], a[132:135], v[72:75], v[132:135]
    ds_read_b128 v[92:95], v28 offset:35840
    v_mul_f32 v239, v127, v199
    v_cvt_pk_bf16_f32 v230, v236, v237
    s_waitcnt lgkmcnt(2)
    v_mfma_f32_16x16x32_bf16 v[136:139], a[128:131], v[76:79], v[136:139]
    v_cvt_pk_bf16_f32 v231, v238, v239
    v_cndmask_b32 v230, v230, v68, s[98:99]
    v_mfma_f32_16x16x32_bf16 v[140:143], a[132:135], v[76:79], v[140:143]
    v_cndmask_b32 v231, v231, v68, s[98:99]
    v_mul_f32 v232, v124, v204
    s_waitcnt lgkmcnt(1)
    v_mfma_f32_16x16x32_bf16 v[128:131], a[136:139], v[88:91], v[128:131]
    ds_read_b128 v[72:75], v28 offset:36864
    v_mul_f32 v233, v125, v205
    v_mfma_f32_16x16x32_bf16 v[132:135], a[140:143], v[88:91], v[132:135]
    ds_read_b128 v[76:79], v28 offset:37888
    v_mul_f32 v234, v126, v206
    v_mul_f32 v235, v127, v207
    s_waitcnt lgkmcnt(2)
    v_mfma_f32_16x16x32_bf16 v[136:139], a[136:139], v[92:95], v[136:139]
    v_exp_f32_e64 v232, v232 clamp
    v_fma_f32 v124, v124, v196, s58
    v_mfma_f32_16x16x32_bf16 v[140:143], a[140:143], v[92:95], v[140:143]
    v_max_f32 v124, s58, v124
    v_exp_f32_e64 v233, v233 clamp
    s_waitcnt lgkmcnt(1)
    v_mfma_f32_16x16x32_bf16 v[128:131], a[144:147], v[72:75], v[128:131]
    ds_read_b128 v[88:91], v28 offset:38912
    v_fma_f32 v125, v125, v197, s58
    v_max_f32 v125, s58, v125
    v_mfma_f32_16x16x32_bf16 v[132:135], a[148:151], v[72:75], v[132:135]
    ds_read_b128 v[92:95], v28 offset:39936
    v_exp_f32_e64 v234, v234 clamp
    s_waitcnt lgkmcnt(2)
    v_mfma_f32_16x16x32_bf16 v[136:139], a[144:147], v[76:79], v[136:139]
    v_fma_f32 v126, v126, v198, s58
    v_max_f32 v126, s58, v126
    v_mfma_f32_16x16x32_bf16 v[140:143], a[148:151], v[76:79], v[140:143]
    v_exp_f32_e64 v235, v235 clamp
    v_fma_f32 v127, v127, v199, s58
    s_waitcnt lgkmcnt(1)
    v_mfma_f32_16x16x32_bf16 v[128:131], a[152:155], v[88:91], v[128:131]
    v_max_f32 v127, s58, v127
    v_add_f32 v124, v124, v232
    v_mfma_f32_16x16x32_bf16 v[132:135], a[156:159], v[88:91], v[132:135]
    v_add_f32 v125, v125, v233
    s_waitcnt lgkmcnt(0)
    v_mfma_f32_16x16x32_bf16 v[136:139], a[152:155], v[92:95], v[136:139]
    v_add_f32 v126, v126, v234
    v_add_f32 v127, v127, v235
    v_mfma_f32_16x16x32_bf16 v[140:143], a[156:159], v[92:95], v[140:143]
    v_cvt_pk_bf16_f32 v218, v124, v125
    v_cvt_pk_bf16_f32 v219, v126, v127
    s_barrier
    v_mfma_f32_16x16x32_bf16 v[160:163], v[208:211], v[228:231], 0
    v_mfma_f32_16x16x32_bf16 v[144:147], v[212:215], v[228:231], 0
    v_mfma_f32_16x16x32_bf16 v[176:179], v[216:219], v[228:231], 0
    v_pk_mul_f32 v[128:129], v[128:129], v[192:193]
    v_pk_mul_f32 v[130:131], v[130:131], v[194:195]
    v_cvt_pk_bf16_f32 v220, v128, v129
    v_cvt_pk_bf16_f32 v221, v130, v131
    v_pk_mul_f32 v[132:133], v[132:133], v[196:197]
    v_pk_mul_f32 v[134:135], v[134:135], v[198:199]
    v_cvt_pk_bf16_f32 v222, v132, v133
    v_cvt_pk_bf16_f32 v223, v134, v135
    v_pk_mul_f32 v[136:137], v[136:137], v[192:193]
    v_pk_mul_f32 v[138:139], v[138:139], v[194:195]
    v_cvt_pk_bf16_f32 v224, v136, v137
    v_cvt_pk_bf16_f32 v225, v138, v139
    v_pk_mul_f32 v[140:141], v[140:141], v[196:197]
    v_pk_mul_f32 v[142:143], v[142:143], v[198:199]
    v_cvt_pk_bf16_f32 v226, v140, v141
    v_cvt_pk_bf16_f32 v227, v142, v143
    v_mfma_f32_16x16x32_bf16 v[152:155], v[208:211], v[220:223], 0
    v_cndmask_b32 v160, v160, v144, s[100:101]
    v_cndmask_b32 v161, v161, v145, s[100:101]
    v_mfma_f32_16x16x32_bf16 v[164:167], v[216:219], v[220:223], 0
    v_cndmask_b32 v162, v162, v146, s[100:101]
    v_cndmask_b32 v163, v163, v147, s[100:101]
    v_mfma_f32_16x16x32_bf16 v[172:175], v[216:219], v[224:227], 0
    ds_write_b128 v36, v[160:163] offset:8192
    v_mfma_f32_16x16x32_bf16 v[156:159], v[212:215], v[224:227], 0
    ds_write_b128 v36, v[152:155]
    s_nop 4
    v_cndmask_b32 v164, v164, v172, s[86:87]
    v_cndmask_b32 v165, v165, v173, s[86:87]
    v_cndmask_b32 v166, v166, v174, s[86:87]
    v_cndmask_b32 v167, v167, v175, s[86:87]
    ds_write_b128 v36, v[156:159] offset:4096
    v_permlane32_swap_b32 v164, v176
    v_permlane32_swap_b32 v165, v177
    v_permlane32_swap_b32 v166, v178
    v_permlane32_swap_b32 v167, v179
    ds_write_b128 v36, v[164:167] offset:12288
    v_mfma_f32_16x16x16_bf16 v[104:107], v[184:185], v[242:243], 0
    v_mfma_f32_16x16x16_bf16 v[108:111], v[184:185], v[244:245], 0
    v_mfma_f32_16x16x16_bf16 v[112:115], v[186:187], v[242:243], 0
    v_mfma_f32_16x16x16_bf16 v[116:119], v[186:187], v[244:245], 0
    v_mfma_f32_16x16x16_bf16 v[120:123], v[188:189], v[242:243], 0
    v_mfma_f32_16x16x16_bf16 v[124:127], v[188:189], v[244:245], 0
    s_waitcnt lgkmcnt(0)
    s_barrier
    ds_read_b128 v[152:155], v37 offset:0
    ds_read_b128 v[156:159], v37 offset:1024
    ds_read_b128 v[160:163], v37 offset:2048
    ds_read_b128 v[164:167], v37 offset:3072
    ds_read_b128 v[72:75], v53 offset:0
    ds_read_b128 v[76:79], v53 offset:1024
    ds_read_b128 v[80:83], v54 offset:0
    s_waitcnt lgkmcnt(5)
    v_pk_add_f32 v[152:153], v[152:153], v[156:157]
    v_pk_add_f32 v[154:155], v[154:155], v[158:159]
    s_waitcnt lgkmcnt(3)
    v_pk_add_f32 v[160:161], v[160:161], v[164:165]
    v_pk_add_f32 v[162:163], v[162:163], v[166:167]
    v_pk_add_f32 v[152:153], v[152:153], v[160:161]
    v_pk_add_f32 v[154:155], v[154:155], v[162:163]
    v_cvt_pk_bf16_f32 v232, v152, v153
    v_cvt_pk_bf16_f32 v234, v152, v153
    v_cvt_pk_bf16_f32 v233, v154, v155
    v_cvt_pk_bf16_f32 v235, v154, v155
    v_permlane32_swap_b32 v232, v234
    s_nop 0
    v_permlane32_swap_b32 v233, v235
    s_mov_b32 exec_hi, 0
    buffer_store_dwordx4 v[232:235], v4, s[28:31], s93 offen sc1
    s_mov_b32 exec_hi, -1
    s_waitcnt lgkmcnt(1)
    v_mfma_f32_16x16x32_bf16 v[104:107], v[72:75], a[0:3], v[104:107]
    ds_read_b128 v[88:91], v53 offset:2560
    s_add_u32 m0, s53, 0
    s_add_u32 s32, s67, 28672
    v_mfma_f32_16x16x32_bf16 v[108:111], v[72:75], a[4:7], v[108:111]
    ds_read_b128 v[92:95], v53 offset:3584
    s_lshr_b32 s46, s44, 3
    s_lshl2_add_u32 s46, s46, s38
    v_mfma_f32_16x16x32_bf16 v[112:115], v[76:79], a[0:3], v[112:115]
    buffer_load_dwordx4 v4, s[28:31], s1 offen sc1 lds
    s_lshl_b32 s46, s46, 7
    v_mfma_f32_16x16x32_bf16 v[116:119], v[76:79], a[4:7], v[116:119]
    ds_read_b128 v[96:99], v54 offset:2560
    s_add_u32 s33, s46, 28672
    s_and_b32 s46, s44, 7
    s_waitcnt lgkmcnt(3)
    v_mfma_f32_16x16x32_bf16 v[120:123], v[80:83], a[0:3], v[120:123]
    s_add_u32 s1, s1, 4096
    s_add_u32 m0, s53, 4096
    s_cmp_eq_u32 s46, 3
    s_cselect_b32 s33, s33, 0x2000000
    v_mfma_f32_16x16x32_bf16 v[124:127], v[80:83], a[4:7], v[124:127]
    buffer_load_dwordx4 v4, s[28:31], s1 offen sc1 lds
    s_cmp_eq_u32 s46, 3
    s_cselect_b32 s34, 16, 0
    s_waitcnt lgkmcnt(1)
    v_mfma_f32_16x16x32_bf16 v[104:107], v[88:91], a[8:11], v[104:107]
    ds_read_b128 v[72:75], v53 offset:5120
    s_add_u32 s1, s1, 4096
    s_lshl2_add_u32 s46, s39, s38
    s_lshl_b32 s93, s46, 7
    v_mfma_f32_16x16x32_bf16 v[108:111], v[88:91], a[12:15], v[108:111]
    ds_read_b128 v[76:79], v53 offset:6144
    s_add_u32 m0, s53, 8192
    s_add_u32 s93, s93, 20480
    v_mfma_f32_16x16x32_bf16 v[112:115], v[92:95], a[8:11], v[112:115]
    buffer_load_dwordx4 v4, s[28:31], s1 offen sc1 lds
    s_mul_i32 s46, s46, 40960
    s_add_u32 s46, s46, 2097152
    v_mfma_f32_16x16x32_bf16 v[116:119], v[92:95], a[12:15], v[116:119]
    ds_read_b128 v[80:83], v54 offset:5120
    s_lshl_b32 s88, s40, 10
    s_waitcnt lgkmcnt(3)
    v_mfma_f32_16x16x32_bf16 v[120:123], v[96:99], a[8:11], v[120:123]
    s_add_u32 s1, s1, 4096
    s_add_u32 m0, s53, 12288
    s_add_u32 s88, s88, s46
    v_mfma_f32_16x16x32_bf16 v[124:127], v[96:99], a[12:15], v[124:127]
    s_barrier
    buffer_load_dwordx4 v4, s[28:31], s1 offen sc1 lds
    s_add_u32 s89, s88, 20480
    s_lshl_b32 s48, s40, 8
    s_waitcnt lgkmcnt(1)
    v_mfma_f32_16x16x32_bf16 v[104:107], v[72:75], a[16:19], v[104:107]
    ds_read_b128 v[88:91], v53 offset:7680
    s_waitcnt vmcnt(5)
    s_barrier
    s_add_u32 s48, s48, s46
    v_mfma_f32_16x16x32_bf16 v[108:111], v[72:75], a[20:23], v[108:111]
    ds_read_b128 v[92:95], v53 offset:8704
    s_cmp_eq_u32 s38, 0
    s_cselect_b32 s57, s32, 0x2000000
    s_add_u32 s48, s48, 16384
    v_mfma_f32_16x16x32_bf16 v[112:115], v[76:79], a[16:19], v[112:115]
    s_mov_b64 exec, 1
    buffer_atomic_add v5, off, s[28:31], s57 sc1
    s_mov_b64 exec, -1
    s_add_u32 s49, s48, 20480
    s_mul_i32 s51, s92, 20480
    v_mfma_f32_16x16x32_bf16 v[116:119], v[76:79], a[20:23], v[116:119]
    ds_read_b128 v[96:99], v54 offset:7680
    s_cmp_ge_u32 s45, 30
    s_cselect_b32 s14, 0, s14
    s_waitcnt lgkmcnt(3)
    v_mfma_f32_16x16x32_bf16 v[120:123], v[80:83], a[16:19], v[120:123]
    s_add_u32 s1, s1, 4096
    s_add_u32 m0, s53, 16384
    v_and_b32 v7, 1, v2
    v_lshlrev_b32 v7, 2, v7
    v_mfma_f32_16x16x32_bf16 v[124:127], v[80:83], a[20:23], v[124:127]
    buffer_load_dwordx4 v4, s[28:31], s1 offen sc1 lds
    v_sub_u32 v7, v3, v7
    s_waitcnt lgkmcnt(1)
    v_mfma_f32_16x16x32_bf16 v[104:107], v[88:91], a[24:27], v[104:107]
    ds_read_b128 v[72:75], v53 offset:10240
    s_add_u32 s1, s1, 4096
    v_and_b32 v8, 1, v7
    v_mfma_f32_16x16x32_bf16 v[108:111], v[88:91], a[28:31], v[108:111]
    ds_read_b128 v[76:79], v53 offset:11264
    s_add_u32 m0, s53, 20480
    v_lshlrev_b32 v8, 4, v8
    v_mov_b32 v9, 0x3f80
    v_mfma_f32_16x16x32_bf16 v[112:115], v[92:95], a[24:27], v[112:115]
    buffer_load_dwordx4 v4, s[28:31], s1 offen sc1 lds
    v_lshlrev_b32 v8, v8, v9
    v_mfma_f32_16x16x32_bf16 v[116:119], v[92:95], a[28:31], v[116:119]
    ds_read_b128 v[80:83], v54 offset:10240
    v_lshrrev_b32 v7, 1, v7
    v_cmp_eq_u32 s[82:83], 0, v7
    s_waitcnt lgkmcnt(3)
    v_mfma_f32_16x16x32_bf16 v[120:123], v[96:99], a[24:27], v[120:123]
    s_add_u32 s1, s1, 4096
    s_add_u32 m0, s53, 24576
    v_cmp_eq_u32 s[62:63], 1, v7
    v_mfma_f32_16x16x32_bf16 v[124:127], v[96:99], a[28:31], v[124:127]
    buffer_load_dwordx4 v4, s[28:31], s1 offen sc1 lds
    v_cndmask_b32 v192, 0, v8, s[82:83]
    s_waitcnt lgkmcnt(1)
    v_mfma_f32_16x16x32_bf16 v[104:107], v[72:75], a[32:35], v[104:107]
    ds_read_b128 v[88:91], v53 offset:12800
    s_add_u32 s1, s1, 4096
    v_cndmask_b32 v193, 0, v8, s[62:63]
    v_cmp_eq_u32 s[82:83], 4, v7
    v_mfma_f32_16x16x32_bf16 v[108:111], v[72:75], a[36:39], v[108:111]
    ds_read_b128 v[92:95], v53 offset:13824
    s_add_u32 m0, s53, 28672
    v_cmp_eq_u32 s[62:63], 5, v7
    v_mfma_f32_16x16x32_bf16 v[112:115], v[76:79], a[32:35], v[112:115]
    buffer_load_dwordx4 v4, s[28:31], s1 offen sc1 lds
    v_cndmask_b32 v194, 0, v8, s[82:83]
    v_cndmask_b32 v195, 0, v8, s[62:63]
    v_mfma_f32_16x16x32_bf16 v[116:119], v[76:79], a[36:39], v[116:119]
    ds_read_b128 v[96:99], v54 offset:12800
    v_lshrrev_b32 v7, 3, v1
    s_waitcnt lgkmcnt(3)
    v_mfma_f32_16x16x32_bf16 v[120:123], v[80:83], a[32:35], v[120:123]
    s_add_u32 s1, s1, 4096
    s_add_u32 m0, s53, 32768
    v_and_b32 v8, 7, v1
    v_mfma_f32_16x16x32_bf16 v[124:127], v[80:83], a[36:39], v[124:127]
    buffer_load_dwordx4 v4, s[28:31], s1 offen sc1 lds
    v_and_b32 v9, 6, v7
    v_xor_b32 v8, v8, v9
    s_waitcnt lgkmcnt(1)
    v_mfma_f32_16x16x32_bf16 v[104:107], v[88:91], a[40:43], v[104:107]
    ds_read_b128 v[72:75], v53 offset:15360
    s_add_u32 s1, s1, 4096
    v_lshlrev_b32 v8, 4, v8
    v_mfma_f32_16x16x32_bf16 v[108:111], v[88:91], a[44:47], v[108:111]
    ds_read_b128 v[76:79], v53 offset:16384
    s_add_u32 m0, s53, 36864
    s_lshr_b32 s46, s44, 3
    s_mul_i32 s46, s46, 262144
    v_mfma_f32_16x16x32_bf16 v[112:115], v[92:95], a[40:43], v[112:115]
    buffer_load_dwordx4 v4, s[28:31], s1 offen sc1 lds
    s_add_u32 s46, s46, 11534336
    v_mfma_f32_16x16x32_bf16 v[116:119], v[92:95], a[44:47], v[116:119]
    ds_read_b128 v[80:83], v54 offset:15360
    s_lshl_b32 s47, s44, 7
    s_waitcnt lgkmcnt(3)
    v_mfma_f32_16x16x32_bf16 v[120:123], v[96:99], a[40:43], v[120:123]
    s_and_b32 s50, s44, 7
    s_cmp_eq_u32 s50, 3
    s_cselect_b32 s46, s46, s47
    v_mfma_f32_16x16x32_bf16 v[124:127], v[96:99], a[44:47], v[124:127]
    s_waitcnt vmcnt(11)
    s_mov_b64 exec, 1
    buffer_atomic_add v60, off, s[28:31], s90 sc1
    s_mov_b64 exec, -1
    s_cmp_eq_u32 s50, 3
    s_cselect_b32 s100, 4, 96
    s_waitcnt lgkmcnt(1)
    v_mfma_f32_16x16x32_bf16 v[104:107], v[72:75], a[48:51], v[104:107]
    ds_read_b128 v[88:91], v53 offset:17920
    s_add_u32 s1, s1, 4096
    s_cmp_eq_u32 s50, 3
    s_cselect_b64 s[12:13], s[28:29], s[12:13]
    v_mfma_f32_16x16x32_bf16 v[108:111], v[72:75], a[52:55], v[108:111]
    ds_read_b128 v[92:95], v53 offset:18944
    s_add_u32 m0, s53, 40960
    s_cmp_eq_u32 s50, 3
    s_cselect_b32 s14, s30, s14
    s_lshl_b32 s50, s100, 5
    v_mfma_f32_16x16x32_bf16 v[112:115], v[76:79], a[48:51], v[112:115]
    buffer_load_dwordx4 v4, s[28:31], s1 offen sc1 lds
    s_mul_i32 s47, s38, 512
    v_mfma_f32_16x16x32_bf16 v[116:119], v[76:79], a[52:55], v[116:119]
    ds_read_b128 v[96:99], v54 offset:17920
    v_add_u32 v9, s47, v7
    v_mad_u32_u24 v9, v9, s50, v8
    s_waitcnt lgkmcnt(3)
    v_mfma_f32_16x16x32_bf16 v[120:123], v[80:83], a[48:51], v[120:123]
    s_add_u32 s1, s1, 4096
    s_add_u32 m0, s53, 45056
    v_add_u32 v12, s46, v9
    v_mfma_f32_16x16x32_bf16 v[124:127], v[80:83], a[52:55], v[124:127]
    buffer_load_dwordx4 v4, s[28:31], s1 offen sc1 lds
    s_lshl_b32 s50, s50, 3
    s_waitcnt lgkmcnt(1)
    v_mfma_f32_16x16x32_bf16 v[104:107], v[88:91], a[56:59], v[104:107]
    ds_read_b128 v[72:75], v53 offset:20480
    s_add_u32 s1, s1, 4096
    s_sub_u32 s50, s50, 1024
    v_add_u32 v13, s50, v12
    v_mfma_f32_16x16x32_bf16 v[108:111], v[88:91], a[60:63], v[108:111]
    ds_read_b128 v[76:79], v53 offset:21504
    s_add_u32 m0, s53, 49152
    v_add_u32 v14, s50, v13
    v_mfma_f32_16x16x32_bf16 v[112:115], v[92:95], a[56:59], v[112:115]
    buffer_load_dwordx4 v4, s[28:31], s1 offen sc1 lds
    v_add_u32 v15, s50, v14
    s_and_b32 s46, s44, 7
    v_mfma_f32_16x16x32_bf16 v[116:119], v[92:95], a[60:63], v[116:119]
    ds_read_b128 v[80:83], v54 offset:20480
    s_cmp_eq_u32 s46, 3
    s_cselect_b32 s47, 12, 12
    s_waitcnt lgkmcnt(3)
    v_mfma_f32_16x16x32_bf16 v[120:123], v[96:99], a[56:59], v[120:123]
    s_add_u32 s1, s1, 4096
    s_add_u32 m0, s53, 53248
    s_cmp_eq_u32 s46, 3
    s_cselect_b32 s46, 8, 8
    v_mfma_f32_16x16x32_bf16 v[124:127], v[96:99], a[60:63], v[124:127]
    buffer_load_dwordx4 v4, s[28:31], s1 offen sc1 lds
    s_mul_i32 s46, s46, s43
    s_bitcmp1_b32 s2, 0
    s_cselect_b32 s47, s47, 0
    s_waitcnt lgkmcnt(1)
    v_mfma_f32_16x16x32_bf16 v[104:107], v[72:75], a[64:67], v[104:107]
    ds_read_b128 v[88:91], v53 offset:23040
    s_add_u32 s1, s1, 4096
    s_add_u32 s46, s46, s47
    v_mfma_f32_16x16x32_bf16 v[108:111], v[72:75], a[68:71], v[108:111]
    ds_read_b128 v[92:95], v53 offset:24064
    s_add_u32 m0, s53, 57344
    s_lshl_b32 s46, s46, 10
    s_and_b32 s64, s46, 0x3c00
    v_mfma_f32_16x16x32_bf16 v[112:115], v[76:79], a[64:67], v[112:115]
    buffer_load_dwordx4 v4, s[28:31], s1 offen sc1 lds
    s_add_u32 s46, s46, 1024
    v_mfma_f32_16x16x32_bf16 v[116:119], v[76:79], a[68:71], v[116:119]
    ds_read_b128 v[96:99], v54 offset:23040
    s_waitcnt lgkmcnt(3)
    v_mfma_f32_16x16x32_bf16 v[120:123], v[80:83], a[64:67], v[120:123]
    s_and_b32 s65, s46, 0x3c00
    s_add_u32 s46, s46, 1024
    s_and_b32 s66, s46, 0x3c00
    v_mfma_f32_16x16x32_bf16 v[124:127], v[80:83], a[68:71], v[124:127]
    v_mov_b32 v51, 0
    s_mov_b64 exec, 1
    buffer_atomic_add v51, v6, s[28:31], s90 offen sc0 sc1
    s_mov_b64 exec, -1
    s_add_u32 s46, s46, 1024
    s_waitcnt lgkmcnt(1)
    v_mfma_f32_16x16x32_bf16 v[104:107], v[88:91], a[72:75], v[104:107]
    ds_read_b128 v[72:75], v53 offset:25600
    s_add_u32 s1, s1, 4096
    s_and_b32 s67, s46, 0x3c00
    s_add_u32 s46, s46, 1024
    v_mfma_f32_16x16x32_bf16 v[108:111], v[88:91], a[76:79], v[108:111]
    ds_read_b128 v[76:79], v53 offset:26624
    s_add_u32 m0, s53, 61440
    s_and_b32 s68, s46, 0x3c00
    v_mfma_f32_16x16x32_bf16 v[112:115], v[92:95], a[72:75], v[112:115]
    buffer_load_dwordx4 v4, s[28:31], s1 offen sc1 lds
    s_add_u32 s46, s46, 1024
    v_mfma_f32_16x16x32_bf16 v[116:119], v[92:95], a[76:79], v[116:119]
    ds_read_b128 v[80:83], v54 offset:25600
    s_and_b32 s69, s46, 0x3c00
    s_add_u32 s46, s46, 1024
    s_waitcnt lgkmcnt(3)
    v_mfma_f32_16x16x32_bf16 v[120:123], v[96:99], a[72:75], v[120:123]
    s_add_u32 s1, s1, 4096
    s_add_u32 m0, s53, 65536
    s_and_b32 s70, s46, 0x3c00
    v_mfma_f32_16x16x32_bf16 v[124:127], v[96:99], a[76:79], v[124:127]
    buffer_load_dwordx4 v4, s[28:31], s1 offen sc1 lds
    s_add_u32 s46, s46, 1024
    s_waitcnt lgkmcnt(1)
    v_mfma_f32_16x16x32_bf16 v[104:107], v[72:75], a[80:83], v[104:107]
    ds_read_b128 v[88:91], v53 offset:28160
    s_add_u32 s1, s1, 4096
    s_and_b32 s71, s46, 0x3c00
    s_add_u32 s46, s46, 1024
    v_mfma_f32_16x16x32_bf16 v[108:111], v[72:75], a[84:87], v[108:111]
    ds_read_b128 v[92:95], v53 offset:29184
    s_add_u32 m0, s53, 69632
    s_and_b32 s72, s46, 0x3c00
    v_mfma_f32_16x16x32_bf16 v[112:115], v[76:79], a[80:83], v[112:115]
    buffer_load_dwordx4 v4, s[28:31], s1 offen sc1 lds
    s_add_u32 s46, s46, 1024
    s_and_b32 s73, s46, 0x3c00
    v_mfma_f32_16x16x32_bf16 v[116:119], v[76:79], a[84:87], v[116:119]
    ds_read_b128 v[96:99], v54 offset:28160
    s_add_u32 s46, s46, 1024
    s_waitcnt lgkmcnt(3)
    v_mfma_f32_16x16x32_bf16 v[120:123], v[80:83], a[80:83], v[120:123]
    s_add_u32 s1, s1, 4096
    s_add_u32 m0, s53, 73728
    s_and_b32 s74, s46, 0x3c00
    v_mfma_f32_16x16x32_bf16 v[124:127], v[80:83], a[84:87], v[124:127]
    buffer_load_dwordx4 v4, s[28:31], s1 offen sc1 lds
    s_add_u32 s46, s46, 1024
    s_and_b32 s75, s46, 0x3c00
    s_waitcnt lgkmcnt(1)
    v_mfma_f32_16x16x32_bf16 v[104:107], v[88:91], a[88:91], v[104:107]
    ds_read_b128 v[72:75], v53 offset:30720
    s_add_u32 s1, s1, 4096
    s_add_u32 s46, s46, 1024
    v_mfma_f32_16x16x32_bf16 v[108:111], v[88:91], a[92:95], v[108:111]
    ds_read_b128 v[76:79], v53 offset:31744
    s_add_u32 m0, s53, 77824
    s_and_b32 s76, s46, 0x3c00
    s_add_u32 s46, s46, 1024
    v_mfma_f32_16x16x32_bf16 v[112:115], v[92:95], a[88:91], v[112:115]
    buffer_load_dwordx4 v4, s[28:31], s1 offen sc1 lds
    s_and_b32 s77, s46, 0x3c00
    v_mfma_f32_16x16x32_bf16 v[116:119], v[92:95], a[92:95], v[116:119]
    ds_read_b128 v[80:83], v54 offset:30720
    s_add_u32 s46, s46, 1024
    s_waitcnt lgkmcnt(3)
    v_mfma_f32_16x16x32_bf16 v[120:123], v[96:99], a[88:91], v[120:123]
    s_add_u32 s1, s1, 4096
    s_add_u32 m0, s53, 81920
    s_and_b32 s78, s46, 0x3c00
    s_add_u32 s46, s46, 1024
    v_mfma_f32_16x16x32_bf16 v[124:127], v[96:99], a[92:95], v[124:127]
    buffer_load_dwordx4 v4, s[28:31], s1 offen sc1 lds
    s_and_b32 s79, s46, 0x3c00
    s_waitcnt lgkmcnt(1)
    v_mfma_f32_16x16x32_bf16 v[104:107], v[72:75], a[96:99], v[104:107]
    ds_read_b128 v[88:91], v53 offset:33280
    s_add_u32 s1, s1, 4096
    s_lshr_b32 s46, s41, 3
    s_mul_i32 s46, s46, 196608
    v_mfma_f32_16x16x32_bf16 v[108:111], v[72:75], a[100:103], v[108:111]
    ds_read_b128 v[92:95], v53 offset:34304
    s_add_u32 m0, s53, 86016
    s_add_u32 s46, s46, 12845056
    v_mfma_f32_16x16x32_bf16 v[112:115], v[76:79], a[96:99], v[112:115]
    buffer_load_dwordx4 v4, s[28:31], s1 offen sc1 lds
    s_lshl_b32 s47, s41, 7
    v_mfma_f32_16x16x32_bf16 v[116:119], v[76:79], a[100:103], v[116:119]
    ds_read_b128 v[96:99], v54 offset:33280
    s_and_b32 s50, s41, 7
    s_cmp_eq_u32 s50, 3
    s_cselect_b32 s46, s46, s47
    s_waitcnt lgkmcnt(3)
    v_mfma_f32_16x16x32_bf16 v[120:123], v[80:83], a[96:99], v[120:123]
    s_add_u32 s1, s1, 4096
    s_add_u32 m0, s53, 90112
    s_cmp_eq_u32 s50, 3
    s_cselect_b32 s101, 4, 128
    v_mfma_f32_16x16x32_bf16 v[124:127], v[80:83], a[100:103], v[124:127]
    buffer_load_dwordx4 v4, s[28:31], s1 offen sc1 lds
    s_lshl_b32 s50, s101, 5
    s_mul_i32 s47, s38, 384
    s_waitcnt lgkmcnt(1)
    v_mfma_f32_16x16x32_bf16 v[104:107], v[88:91], a[104:107], v[104:107]
    ds_read_b128 v[72:75], v53 offset:35840
    s_add_u32 s1, s1, 4096
    v_add_u32 v9, s47, v7
    v_mfma_f32_16x16x32_bf16 v[108:111], v[88:91], a[108:111], v[108:111]
    ds_read_b128 v[76:79], v53 offset:36864
    s_add_u32 m0, s53, 94208
    v_mad_u32_u24 v9, v9, s50, v8
    v_mfma_f32_16x16x32_bf16 v[112:115], v[92:95], a[104:107], v[112:115]
    buffer_load_dwordx4 v4, s[28:31], s1 offen sc1 lds
    v_add_u32 v16, s46, v9
    s_lshl_b32 s50, s50, 3
    v_mfma_f32_16x16x32_bf16 v[116:119], v[92:95], a[108:111], v[116:119]
    ds_read_b128 v[80:83], v54 offset:35840
    s_sub_u32 s50, s50, 1024
    s_waitcnt lgkmcnt(3)
    v_mfma_f32_16x16x32_bf16 v[120:123], v[96:99], a[104:107], v[120:123]
    s_add_u32 s1, s1, 4096
    s_add_u32 m0, s53, 98304
    v_add_u32 v17, s50, v16
    v_add_u32 v18, s50, v17
    v_mfma_f32_16x16x32_bf16 v[124:127], v[96:99], a[108:111], v[124:127]
    buffer_load_dwordx4 v4, s[28:31], s1 offen sc1 lds
    v_add_u32 v19, s50, v18
    s_waitcnt lgkmcnt(1)
    v_mfma_f32_16x16x32_bf16 v[104:107], v[72:75], a[112:115], v[104:107]
    ds_read_b128 v[88:91], v53 offset:38400
    v_lshrrev_b32 v7, 5, v1
    v_mfma_f32_16x16x32_bf16 v[108:111], v[72:75], a[116:119], v[108:111]
    ds_read_b128 v[92:95], v53 offset:39424
    v_bfe_u32 v8, v1, 2, 3
    v_lshl_add_u32 v7, v7, 4, v8
    v_mfma_f32_16x16x32_bf16 v[112:115], v[76:79], a[112:115], v[112:115]
    v_mov_b32 v61, 0
    s_mov_b64 exec, 1
    buffer_atomic_add v61, v6, s[28:31], s33 offen sc0 sc1
    s_mov_b64 exec, -1
    v_lshlrev_b32 v7, 7, v7
    v_mfma_f32_16x16x32_bf16 v[116:119], v[76:79], a[116:119], v[116:119]
    ds_read_b128 v[96:99], v54 offset:38400
    v_and_b32 v9, 3, v1
    s_waitcnt lgkmcnt(3)
    v_mfma_f32_16x16x32_bf16 v[120:123], v[80:83], a[112:115], v[120:123]
    s_waitcnt vmcnt(11)
    v_readfirstlane_b32 s0, v51
    s_nop 0
    s_andn2_b32 s3, 0x3, s0
    s_cselect_b32 s3, 0x2000000, s91
    v_lshl_add_u32 v7, v9, 3, v7
    v_lshrrev_b32 v8, 1, v8
    v_mfma_f32_16x16x32_bf16 v[124:127], v[80:83], a[116:119], v[124:127]
    buffer_load_dwordx4 v[152:155], v4, s[28:31], s3 offen offset:0 sc1
    s_mul_i32 s55, s38, 20480
    s_waitcnt lgkmcnt(1)
    v_mfma_f32_16x16x32_bf16 v[104:107], v[88:91], a[120:123], v[104:107]
    ds_read_b128 v[72:75], v53 offset:40960
    s_andn2_b32 s3, 0xc, s0
    s_cselect_b32 s3, 0x2000000, s91
    s_add_u32 s46, s38, 0
    s_and_b32 s46, s46, 3
    v_mfma_f32_16x16x32_bf16 v[108:111], v[88:91], a[124:127], v[108:111]
    ds_read_b128 v[76:79], v53 offset:41984
    v_xor_b32 v9, s46, v8
    v_mfma_f32_16x16x32_bf16 v[112:115], v[92:95], a[120:123], v[112:115]
    buffer_load_dwordx4 v[156:159], v4, s[28:31], s3 offen offset:1024 sc1
    v_mfma_f32_16x16x32_bf16 v[116:119], v[92:95], a[124:127], v[116:119]
    ds_read_b128 v[80:83], v54 offset:40960
    s_waitcnt lgkmcnt(3)
    v_mfma_f32_16x16x32_bf16 v[120:123], v[96:99], a[120:123], v[120:123]
    s_andn2_b32 s3, 0x30, s0
    s_cselect_b32 s3, 0x2000000, s91
    v_lshl_add_u32 v9, v9, 5, v7
    v_mfma_f32_16x16x32_bf16 v[124:127], v[96:99], a[124:127], v[124:127]
    buffer_load_dwordx4 v[160:163], v4, s[28:31], s3 offen offset:2048 sc1
    s_waitcnt lgkmcnt(1)
    v_mfma_f32_16x16x32_bf16 v[104:107], v[72:75], a[128:131], v[104:107]
    ds_read_b128 v[88:91], v53 offset:43520
    s_andn2_b32 s3, 0xc0, s0
    s_cselect_b32 s3, 0x2000000, s91
    v_mfma_f32_16x16x32_bf16 v[108:111], v[72:75], a[132:135], v[108:111]
    ds_read_b128 v[92:95], v53 offset:44544
    v_add_u32 v20, s52, v9
    v_mfma_f32_16x16x32_bf16 v[112:115], v[76:79], a[128:131], v[112:115]
    buffer_load_dwordx4 v[164:167], v4, s[28:31], s3 offen offset:3072 sc1
    v_mfma_f32_16x16x32_bf16 v[116:119], v[76:79], a[132:135], v[116:119]
    ds_read_b128 v[96:99], v54 offset:43520
    s_waitcnt lgkmcnt(3)
    v_mfma_f32_16x16x32_bf16 v[120:123], v[80:83], a[128:131], v[120:123]
    s_add_u32 s91, s91, 4096
    s_andn2_b32 s3, 0x300, s0
    s_cselect_b32 s3, 0x2000000, s91
    v_mfma_f32_16x16x32_bf16 v[124:127], v[80:83], a[132:135], v[124:127]
    buffer_load_dwordx4 v[168:171], v4, s[28:31], s3 offen offset:0 sc1
    s_waitcnt lgkmcnt(1)
    v_mfma_f32_16x16x32_bf16 v[104:107], v[88:91], a[136:139], v[104:107]
    ds_read_b128 v[72:75], v53 offset:46080
    v_add_u32 v24, s55, v9
    v_mfma_f32_16x16x32_bf16 v[108:111], v[88:91], a[140:143], v[108:111]
    ds_read_b128 v[76:79], v53 offset:47104
    s_add_u32 s46, s38, 1
    v_mfma_f32_16x16x32_bf16 v[112:115], v[92:95], a[136:139], v[112:115]
    v_mov_b32 v50, 0
    s_mov_b64 exec, 1
    buffer_atomic_add v50, v6, s[28:31], s90 offen sc0 sc1
    s_mov_b64 exec, -1
    v_mfma_f32_16x16x32_bf16 v[116:119], v[92:95], a[140:143], v[116:119]
    ds_read_b128 v[80:83], v54 offset:46080
    s_waitcnt lgkmcnt(3)
    v_mfma_f32_16x16x32_bf16 v[120:123], v[96:99], a[136:139], v[120:123]
    s_and_b32 s46, s46, 3
    v_xor_b32 v9, s46, v8
    v_lshl_add_u32 v9, v9, 5, v7
    v_mfma_f32_16x16x32_bf16 v[124:127], v[96:99], a[140:143], v[124:127]
    s_andn2_b32 s3, 0xc00, s0
    s_cselect_b32 s3, 0x2000000, s91
    s_waitcnt lgkmcnt(1)
    v_mfma_f32_16x16x32_bf16 v[104:107], v[72:75], a[144:147], v[104:107]
    ds_read_b128 v[88:91], v53 offset:48640
    v_add_u32 v21, s52, v9
    v_mfma_f32_16x16x32_bf16 v[108:111], v[72:75], a[148:151], v[108:111]
    ds_read_b128 v[92:95], v53 offset:49664
    v_add_u32 v25, s55, v9
    v_mfma_f32_16x16x32_bf16 v[112:115], v[76:79], a[144:147], v[112:115]
    buffer_load_dwordx4 v[172:175], v4, s[28:31], s3 offen offset:1024 sc1
    v_mfma_f32_16x16x32_bf16 v[116:119], v[76:79], a[148:151], v[116:119]
    ds_read_b128 v[96:99], v54 offset:48640
    s_waitcnt lgkmcnt(3)
    v_mfma_f32_16x16x32_bf16 v[120:123], v[80:83], a[144:147], v[120:123]
    s_andn2_b32 s3, 0x3000, s0
    s_cselect_b32 s3, 0x2000000, s91
    s_add_u32 s46, s38, 2
    v_mfma_f32_16x16x32_bf16 v[124:127], v[80:83], a[148:151], v[124:127]
    s_and_b32 s46, s46, 3
    v_xor_b32 v9, s46, v8
    v_lshl_add_u32 v9, v9, 5, v7
    v_add_u32 v22, s52, v9
    v_add_u32 v26, s55, v9
    s_add_u32 s46, s38, 3
    s_waitcnt lgkmcnt(1)
    v_mfma_f32_16x16x32_bf16 v[104:107], v[88:91], a[152:155], v[104:107]
    s_and_b32 s46, s46, 3
    v_xor_b32 v9, s46, v8
    v_lshl_add_u32 v9, v9, 5, v7
    v_add_u32 v23, s52, v9
    v_add_u32 v27, s55, v9
    v_lshrrev_b32 v7, 2, v1
    v_mul_u32_u24 v7, 160, v7
    v_and_b32 v8, 3, v1
    v_lshl_add_u32 v7, v8, 3, v7
    v_add_u32 v32, s52, v7
    s_lshr_b32 s39, s92, 1
    v_mfma_f32_16x16x32_bf16 v[108:111], v[88:91], a[156:159], v[108:111]
    s_lshl_b32 s39, s39, 7
    s_add_u32 s39, s39, 20480
    s_mul_i32 s40, s92, 20480
    v_mfma_f32_16x16x32_bf16 v[112:115], v[92:95], a[152:155], v[112:115]
    buffer_load_dwordx4 v[176:179], v4, s[28:31], s3 offen offset:2048 sc1
    v_mfma_f32_16x16x32_bf16 v[116:119], v[92:95], a[156:159], v[116:119]
    s_andn2_b32 s3, 0xc000, s0
    s_cselect_b32 s3, 0x2000000, s91
    s_waitcnt lgkmcnt(0)
    v_mfma_f32_16x16x32_bf16 v[120:123], v[96:99], a[152:155], v[120:123]
    s_add_u32 s40, s40, 2097152
    v_lshrrev_b32 v33, 3, v1
    v_lshlrev_b32 v33, 4, v33
    v_and_b32 v8, 7, v1
    v_lshl_add_u32 v34, v8, 7, v33
    v_cmp_lt_u32 s[60:61], 7, v3
    v_lshrrev_b32 v7, 5, v1
    v_mul_u32_u24 v7, 65024, v7
    v_mfma_f32_16x16x32_bf16 v[124:127], v[96:99], a[156:159], v[124:127]
    buffer_load_dwordx4 v[180:183], v4, s[28:31], s3 offen offset:3072 sc1
    v_add_u32 v35, v7, v4
    s_barrier
    v_pk_mul_f32 v[232:233], v[104:105], v[250:251] op_sel_hi:[1,0]
    v_pk_mul_f32 v[234:235], v[106:107], v[250:251] op_sel_hi:[1,0]
    v_pk_fma_f32 v[104:105], v[104:105], v[246:247], s[58:59] op_sel_hi:[1,0,1]
    v_pk_fma_f32 v[106:107], v[106:107], v[246:247], s[58:59] op_sel_hi:[1,0,1]
    v_exp_f32_e64 v232, v232 clamp
    v_exp_f32_e64 v233, v233 clamp
    v_exp_f32_e64 v234, v234 clamp
    v_exp_f32_e64 v235, v235 clamp
    v_max_f32_e64 v104, s58, v104
    v_max_f32_e64 v105, s58, v105
    v_max_f32_e64 v106, s58, v106
    v_max_f32_e64 v107, s58, v107
    v_pk_add_f32 v[104:105], v[104:105], v[232:233]
    v_pk_add_f32 v[106:107], v[106:107], v[234:235]
    v_cvt_pk_bf16_f32 v72, v104, v105
    v_cvt_pk_bf16_f32 v73, v106, v107
    v_pk_mul_f32 v[232:233], v[108:109], v[252:253] op_sel_hi:[1,0]
    v_pk_mul_f32 v[234:235], v[110:111], v[252:253] op_sel_hi:[1,0]
    v_pk_fma_f32 v[108:109], v[108:109], v[248:249], s[58:59] op_sel_hi:[1,0,1]
    v_pk_fma_f32 v[110:111], v[110:111], v[248:249], s[58:59] op_sel_hi:[1,0,1]
    v_exp_f32_e64 v232, v232 clamp
    v_exp_f32_e64 v233, v233 clamp
    v_exp_f32_e64 v234, v234 clamp
    v_exp_f32_e64 v235, v235 clamp
    v_max_f32_e64 v108, s58, v108
    v_max_f32_e64 v109, s58, v109
    v_max_f32_e64 v110, s58, v110
    v_max_f32_e64 v111, s58, v111
    v_pk_add_f32 v[108:109], v[108:109], v[232:233]
    v_pk_add_f32 v[110:111], v[110:111], v[234:235]
    v_cvt_pk_bf16_f32 v80, v108, v109
    v_cvt_pk_bf16_f32 v81, v110, v111
    v_pk_mul_f32 v[232:233], v[112:113], v[250:251] op_sel_hi:[1,0]
    v_pk_mul_f32 v[234:235], v[114:115], v[250:251] op_sel_hi:[1,0]
    v_pk_fma_f32 v[112:113], v[112:113], v[246:247], s[58:59] op_sel_hi:[1,0,1]
    v_pk_fma_f32 v[114:115], v[114:115], v[246:247], s[58:59] op_sel_hi:[1,0,1]
    v_exp_f32_e64 v232, v232 clamp
    v_exp_f32_e64 v233, v233 clamp
    v_exp_f32_e64 v234, v234 clamp
    v_exp_f32_e64 v235, v235 clamp
    v_max_f32_e64 v112, s58, v112
    v_max_f32_e64 v113, s58, v113
    v_max_f32_e64 v114, s58, v114
    v_max_f32_e64 v115, s58, v115
    v_pk_add_f32 v[112:113], v[112:113], v[232:233]
    v_pk_add_f32 v[114:115], v[114:115], v[234:235]
    v_cvt_pk_bf16_f32 v76, v112, v113
    v_cvt_pk_bf16_f32 v77, v114, v115
    v_pk_mul_f32 v[232:233], v[116:117], v[252:253] op_sel_hi:[1,0]
    v_pk_mul_f32 v[234:235], v[118:119], v[252:253] op_sel_hi:[1,0]
    v_pk_fma_f32 v[116:117], v[116:117], v[248:249], s[58:59] op_sel_hi:[1,0,1]
    v_pk_fma_f32 v[118:119], v[118:119], v[248:249], s[58:59] op_sel_hi:[1,0,1]
    v_exp_f32_e64 v232, v232 clamp
    v_exp_f32_e64 v233, v233 clamp
    v_exp_f32_e64 v234, v234 clamp
    v_exp_f32_e64 v235, v235 clamp
    v_max_f32_e64 v116, s58, v116
    v_max_f32_e64 v117, s58, v117
    v_max_f32_e64 v118, s58, v118
    v_max_f32_e64 v119, s58, v119
    v_pk_add_f32 v[116:117], v[116:117], v[232:233]
    v_pk_add_f32 v[118:119], v[118:119], v[234:235]
    v_cvt_pk_bf16_f32 v84, v116, v117
    v_cvt_pk_bf16_f32 v85, v118, v119
    s_cmpk_lg_u32 s0, 0xffff
    s_cbranch_scc1 L_regather_10
L_gathered_11:
    v_pk_mul_f32 v[232:233], v[120:121], v[250:251] op_sel_hi:[1,0]
    v_pk_mul_f32 v[234:235], v[122:123], v[250:251] op_sel_hi:[1,0]
    v_pk_fma_f32 v[120:121], v[120:121], v[246:247], s[58:59] op_sel_hi:[1,0,1]
    v_pk_fma_f32 v[122:123], v[122:123], v[246:247], s[58:59] op_sel_hi:[1,0,1]
    v_exp_f32_e64 v232, v232 clamp
    v_exp_f32_e64 v233, v233 clamp
    v_exp_f32_e64 v234, v234 clamp
    v_exp_f32_e64 v235, v235 clamp
    v_max_f32_e64 v120, s58, v120
    v_max_f32_e64 v121, s58, v121
    v_max_f32_e64 v122, s58, v122
    v_max_f32_e64 v123, s58, v123
    v_pk_add_f32 v[120:121], v[120:121], v[232:233]
    v_pk_add_f32 v[122:123], v[122:123], v[234:235]
    v_cvt_pk_bf16_f32 v74, v120, v121
    v_cvt_pk_bf16_f32 v75, v122, v123
    v_cvt_pk_bf16_f32 v78, v120, v121
    v_cvt_pk_bf16_f32 v79, v122, v123
    v_pk_mul_f32 v[232:233], v[124:125], v[252:253] op_sel_hi:[1,0]
    v_pk_mul_f32 v[234:235], v[126:127], v[252:253] op_sel_hi:[1,0]
    v_pk_fma_f32 v[124:125], v[124:125], v[248:249], s[58:59] op_sel_hi:[1,0,1]
    v_pk_fma_f32 v[126:127], v[126:127], v[248:249], s[58:59] op_sel_hi:[1,0,1]
    v_exp_f32_e64 v232, v232 clamp
    v_exp_f32_e64 v233, v233 clamp
    v_exp_f32_e64 v234, v234 clamp
    v_exp_f32_e64 v235, v235 clamp
    v_max_f32_e64 v124, s58, v124
    v_max_f32_e64 v125, s58, v125
    v_max_f32_e64 v126, s58, v126
    v_max_f32_e64 v127, s58, v127
    v_pk_add_f32 v[124:125], v[124:125], v[232:233]
    v_pk_add_f32 v[126:127], v[126:127], v[234:235]
    v_cvt_pk_bf16_f32 v82, v124, v125
    v_cvt_pk_bf16_f32 v83, v126, v127
    v_cvt_pk_bf16_f32 v86, v124, v125
    v_cvt_pk_bf16_f32 v87, v126, v127
    s_waitcnt vmcnt(0)
    v_mfma_f32_16x16x32_bf16 v[196:199], v[192:195], v[152:155], 0
    v_mfma_f32_16x16x32_bf16 v[196:199], v[192:195], v[156:159], v[196:199]
    v_mfma_f32_16x16x32_bf16 v[196:199], v[192:195], v[160:163], v[196:199]
    v_mfma_f32_16x16x32_bf16 v[196:199], v[192:195], v[164:167], v[196:199]
    v_mfma_f32_16x16x32_bf16 v[196:199], v[192:195], v[168:171], v[196:199]
    v_mfma_f32_16x16x32_bf16 v[196:199], v[192:195], v[172:175], v[196:199]
    v_mfma_f32_16x16x32_bf16 v[196:199], v[192:195], v[176:179], v[196:199]
    s_add_u32 m0, s52, 8192
    v_mfma_f32_16x16x32_bf16 v[196:199], v[192:195], v[180:183], v[196:199]
    buffer_load_dwordx4 v57, s[4:7], s51 offen lds
    v_cmp_gt_u32 vcc, s34, v61
    s_mov_b32 s57, 0
    s_and_b32 vcc_lo, vcc_lo, 1
    s_cbranch_scc1 L_slow_X_22
L_back_X_23:
    s_add_u32 m0, s52, 9216
    s_nop 0
    buffer_load_dwordx4 v58, s[4:7], s51 offen lds
    v_cvt_pk_bf16_f32 v196, v196, v197
    v_cvt_pk_bf16_f32 v197, v198, v199
    s_add_u32 m0, s52, 10240
    ds_write_b64 v48, v[196:197]
    buffer_load_dwordx4 v59, s[4:7], s51 offen lds
    s_waitcnt lgkmcnt(0)
    s_barrier
    ds_read_b64 v[88:89], v45 offset:0
    ds_read_b64 v[90:91], v46 offset:0
    ds_read_b64 v[92:93], v45 offset:32
    ds_read_b64 v[94:95], v47 offset:0
    ds_read_b64 v[216:217], v38 offset:0
    ds_read_b64 v[218:219], v39 offset:0
    ds_read_b64 v[220:221], v38 offset:512
    ds_read_b64 v[222:223], v40 offset:0
    ds_read_b64 v[224:225], v41 offset:0
    ds_read_b64 v[226:227], v43 offset:0
    ds_read_b64 v[228:229], v42 offset:0
    ds_read_b64 v[230:231], v44 offset:0
    s_waitcnt lgkmcnt(8)
    v_mfma_f32_16x16x32_bf16 v[124:127], v[88:91], v[72:75], 0
    v_mfma_f32_16x16x32_bf16 v[128:131], v[92:95], v[76:79], 0
    v_mfma_f32_16x16x32_bf16 v[144:147], v[88:91], v[80:83], 0
    v_mfma_f32_16x16x32_bf16 v[148:151], v[92:95], v[84:87], 0
    s_waitcnt lgkmcnt(4)
    v_mfma_f32_16x16x32_bf16 v[112:115], v[216:219], v[72:75], 0
    v_mfma_f32_16x16x32_bf16 v[116:119], v[220:223], v[76:79], 0
    v_mfma_f32_16x16x32_bf16 v[132:135], v[216:219], v[80:83], 0
    v_mfma_f32_16x16x32_bf16 v[136:139], v[220:223], v[84:87], 0
    v_add_f32 v124, s58, v124
    v_add_f32 v128, s58, v128
    v_add_f32 v144, s58, v144
    v_add_f32 v148, s58, v148
    s_waitcnt lgkmcnt(0)
    v_mfma_f32_16x16x32_bf16 v[120:123], v[224:227], v[72:75], 0
    v_rcp_f32 v124, v124
    v_mfma_f32_16x16x32_bf16 v[140:143], v[224:227], v[80:83], 0
    v_rcp_f32 v128, v128
    v_mfma_f32_16x16x32_bf16 v[120:123], v[228:231], v[76:79], v[120:123]
    v_rcp_f32 v144, v144
    v_mfma_f32_16x16x32_bf16 v[140:143], v[228:231], v[84:87], v[140:143]
    v_rcp_f32 v148, v148
    v_cndmask_b32 v126, v124, v128, s[86:87]
    v_pk_mul_f32 v[112:113], v[112:113], v[124:125] op_sel_hi:[1,0]
    v_pk_mul_f32 v[116:117], v[116:117], v[128:129] op_sel_hi:[1,0]
    v_pk_mul_f32 v[114:115], v[114:115], v[124:125] op_sel_hi:[1,0]
    v_pk_mul_f32 v[118:119], v[118:119], v[128:129] op_sel_hi:[1,0]
    v_cvt_pk_bf16_f32 v160, v112, v113
    v_cvt_pk_bf16_f32 v161, v114, v115
    v_cvt_pk_bf16_f32 v162, v116, v117
    v_cvt_pk_bf16_f32 v163, v118, v119
    buffer_store_dwordx4 v[160:163], v4, s[28:31], s88 offen sc1
    v_cndmask_b32 v146, v144, v148, s[86:87]
    v_pk_mul_f32 v[132:133], v[132:133], v[144:145] op_sel_hi:[1,0]
    v_pk_mul_f32 v[136:137], v[136:137], v[148:149] op_sel_hi:[1,0]
    v_pk_mul_f32 v[134:135], v[134:135], v[144:145] op_sel_hi:[1,0]
    v_pk_mul_f32 v[138:139], v[138:139], v[148:149] op_sel_hi:[1,0]
    v_cvt_pk_bf16_f32 v164, v132, v133
    v_cvt_pk_bf16_f32 v165, v134, v135
    v_cvt_pk_bf16_f32 v166, v136, v137
    v_cvt_pk_bf16_f32 v167, v138, v139
    buffer_store_dwordx4 v[164:167], v4, s[28:31], s89 offen sc1
    v_pk_mul_f32 v[120:121], v[120:121], v[126:127] op_sel_hi:[1,0]
    v_pk_mul_f32 v[122:123], v[122:123], v[126:127] op_sel_hi:[1,0]
    v_cvt_pk_bf16_f32 v168, v120, v121
    v_cvt_pk_bf16_f32 v169, v122, v123
    v_pk_mul_f32 v[140:141], v[140:141], v[146:147] op_sel_hi:[1,0]
    v_pk_mul_f32 v[142:143], v[142:143], v[146:147] op_sel_hi:[1,0]
    v_cvt_pk_bf16_f32 v170, v140, v141
    v_cvt_pk_bf16_f32 v171, v142, v143
    s_mov_b32 exec_hi, 0
    buffer_store_dwordx2 v[168:169], v49, s[28:31], s48 offen sc1
    buffer_store_dwordx2 v[170:171], v49, s[28:31], s49 offen sc1
    s_mov_b32 exec_hi, -1
    s_mul_i32 s54, s64, s100
    s_add_u32 m0, s52, 0
    s_nop 0
    buffer_load_dwordx4 v12, s[12:15], s54 offen offset:0 sc1 lds
    buffer_load_dwordx4 v13, s[12:15], s54 offen offset:1024 sc1 lds
    buffer_load_dwordx4 v14, s[12:15], s54 offen offset:2048 sc1 lds
    buffer_load_dwordx4 v15, s[12:15], s54 offen offset:3072 sc1 lds
    s_mul_i32 s54, s65, s100
    s_add_u32 m0, s52, 4096
    s_nop 0
    buffer_load_dwordx4 v12, s[12:15], s54 offen offset:0 sc1 lds
    buffer_load_dwordx4 v13, s[12:15], s54 offen offset:1024 sc1 lds
    buffer_load_dwordx4 v14, s[12:15], s54 offen offset:2048 sc1 lds
    buffer_load_dwordx4 v15, s[12:15], s54 offen offset:3072 sc1 lds
    s_waitcnt vmcnt(12)
    ds_read_b64_tr_b16 v[176:177], v32 offset:8192
    ds_read_b64_tr_b16 v[178:179], v32 offset:8224
    ds_read_b64_tr_b16 v[180:181], v32 offset:8256
    ds_read_b64_tr_b16 v[182:183], v32 offset:8288
    ds_read_b64_tr_b16 v[184:185], v32 offset:8320
    s_waitcnt lgkmcnt(0)
    s_mul_i32 s54, s66, s100
    s_add_u32 m0, s52, 8192
    s_nop 0
    buffer_load_dwordx4 v12, s[12:15], s54 offen offset:0 sc1 lds
    buffer_load_dwordx4 v13, s[12:15], s54 offen offset:1024 sc1 lds
    buffer_load_dwordx4 v14, s[12:15], s54 offen offset:2048 sc1 lds
    buffer_load_dwordx4 v15, s[12:15], s54 offen offset:3072 sc1 lds
    v_lshlrev_b32 v36, 16, v176
    v_and_b32 v37, 0xffff0000, v176
    v_lshlrev_b32 v38, 16, v177
    v_and_b32 v39, 0xffff0000, v177
    v_lshlrev_b32 v40, 16, v178
    v_and_b32 v41, 0xffff0000, v178
    v_lshlrev_b32 v42, 16, v179
    v_and_b32 v43, 0xffff0000, v179
    v_lshlrev_b32 v44, 16, v180
    v_and_b32 v45, 0xffff0000, v180
    v_lshlrev_b32 v46, 16, v181
    v_and_b32 v47, 0xffff0000, v181
    v_lshlrev_b32 v48, 16, v182
    v_and_b32 v49, 0xffff0000, v182
    v_lshlrev_b32 v50, 16, v183
    v_and_b32 v51, 0xffff0000, v183
    v_lshlrev_b32 v52, 16, v184
    v_and_b32 v53, 0xffff0000, v184
    v_lshlrev_b32 v54, 16, v185
    v_and_b32 v55, 0xffff0000, v185
    ds_read_b128 v[56:59], v4 offset:0
    ds_read_b128 v[60:63], v4 offset:20480
    ds_read_b128 v[64:67], v4 offset:40960
    ds_read_b128 v[68:71], v28 offset:0
    ds_read_b128 v[72:75], v28 offset:20480
    ds_read_b128 v[76:79], v4 offset:1024
    ds_read_b128 v[80:83], v4 offset:21504
    ds_read_b128 v[84:87], v4 offset:41984
    ds_read_b128 v[88:91], v28 offset:1024
    ds_read_b128 v[92:95], v28 offset:21504
    ds_read_b128 v[96:99], v4 offset:2048
    ds_read_b128 v[100:103], v4 offset:22528
    ds_read_b128 v[104:107], v4 offset:43008
    ds_read_b128 v[108:111], v28 offset:2048
    ds_read_b128 v[112:115], v28 offset:22528
    ds_read_b128 v[116:119], v4 offset:3072
    ds_read_b128 v[120:123], v4 offset:23552
    ds_read_b128 v[124:127], v4 offset:44032
    ds_read_b128 v[128:131], v28 offset:3072
    ds_read_b128 v[132:135], v28 offset:23552
    ds_read_b128 v[136:139], v4 offset:4096
    ds_read_b128 v[140:143], v4 offset:24576
    ds_read_b128 v[144:147], v4 offset:45056
    ds_read_b128 v[148:151], v28 offset:4096
    ds_read_b128 v[152:155], v28 offset:24576
    ds_read_b128 v[156:159], v4 offset:5120
    ds_read_b128 v[160:163], v4 offset:25600
    ds_read_b128 v[164:167], v4 offset:46080
    ds_read_b128 v[168:171], v28 offset:5120
    ds_read_b128 v[172:175], v28 offset:25600
    s_waitcnt vmcnt(12)
    s_mov_b64 exec, 1
    buffer_atomic_add v5, off, s[28:31], s93 sc1
    s_mov_b64 exec, -1
    s_and_b32 s46, s41, 7
    s_cmp_eq_u32 s46, 3
    s_cselect_b64 s[16:17], s[28:29], s[16:17]
    s_cselect_b32 s18, s30, s18
    s_cselect_b32 s46, 1, 1
    s_cselect_b32 s47, 3, 3
    s_cselect_b32 s56, 6, 6
    s_and_b32 s46, s46, s42
    s_mul_i32 s46, s46, s47
    s_bitcmp1_b32 s2, 0
    s_cselect_b32 s56, s56, 0
    s_add_u32 s46, s46, s56
    s_lshl_b32 s4, s46, 10
    s_add_u32 s5, s4, 1024
    s_cmpk_eq_u32 s5, 12288
    s_cselect_b32 s5, 0, s5
    s_add_u32 s6, s5, 1024
    s_cmpk_eq_u32 s6, 12288
    s_cselect_b32 s6, 0, s6
    s_add_u32 s7, s6, 1024
    s_cmpk_eq_u32 s7, 12288
    s_cselect_b32 s7, 0, s7
    s_add_u32 s8, s7, 1024
    s_cmpk_eq_u32 s8, 12288
    s_cselect_b32 s8, 0, s8
    s_add_u32 s9, s8, 1024
    s_cmpk_eq_u32 s9, 12288
    s_cselect_b32 s9, 0, s9
    s_add_u32 s10, s9, 1024
    s_cmpk_eq_u32 s10, 12288
    s_cselect_b32 s10, 0, s10
    s_add_u32 s11, s10, 1024
    s_cmpk_eq_u32 s11, 12288
    s_cselect_b32 s11, 0, s11
    s_add_u32 s20, s11, 1024
    s_cmpk_eq_u32 s20, 12288
    s_cselect_b32 s20, 0, s20
    s_add_u32 s21, s20, 1024
    s_cmpk_eq_u32 s21, 12288
    s_cselect_b32 s21, 0, s21
    s_add_u32 s22, s21, 1024
    s_cmpk_eq_u32 s22, 12288
    s_cselect_b32 s22, 0, s22
    s_add_u32 s23, s22, 1024
    s_cmpk_eq_u32 s23, 12288
    s_cselect_b32 s23, 0, s23
    s_waitcnt vmcnt(9)
    ds_read_b64_tr_b16 a[0:1], v20 offset:0
    ds_read_b64_tr_b16 a[2:3], v20 offset:1024
    ds_read_b64_tr_b16 a[4:5], v21 offset:0
    ds_read_b64_tr_b16 a[6:7], v21 offset:1024
    ds_read_b64_tr_b16 a[8:9], v22 offset:0
    ds_read_b64_tr_b16 a[10:11], v22 offset:1024
    ds_read_b64_tr_b16 a[12:13], v23 offset:0
    ds_read_b64_tr_b16 a[14:15], v23 offset:1024
    s_waitcnt lgkmcnt(0)
    s_mul_i32 s54, s67, s100
    s_add_u32 m0, s52, 0
    s_nop 0
    buffer_load_dwordx4 v12, s[12:15], s54 offen offset:0 sc1 lds
    buffer_load_dwordx4 v13, s[12:15], s54 offen offset:1024 sc1 lds
    buffer_load_dwordx4 v14, s[12:15], s54 offen offset:2048 sc1 lds
    buffer_load_dwordx4 v15, s[12:15], s54 offen offset:3072 sc1 lds
    s_waitcnt vmcnt(9)
    ds_read_b64_tr_b16 a[16:17], v20 offset:4096
    ds_read_b64_tr_b16 a[18:19], v20 offset:5120
    ds_read_b64_tr_b16 a[20:21], v21 offset:4096
    ds_read_b64_tr_b16 a[22:23], v21 offset:5120
    ds_read_b64_tr_b16 a[24:25], v22 offset:4096
    ds_read_b64_tr_b16 a[26:27], v22 offset:5120
    ds_read_b64_tr_b16 a[28:29], v23 offset:4096
    ds_read_b64_tr_b16 a[30:31], v23 offset:5120
    s_waitcnt lgkmcnt(0)
    s_mul_i32 s54, s68, s100
    s_add_u32 m0, s52, 4096
    s_nop 0
    buffer_load_dwordx4 v12, s[12:15], s54 offen offset:0 sc1 lds
    buffer_load_dwordx4 v13, s[12:15], s54 offen offset:1024 sc1 lds
    buffer_load_dwordx4 v14, s[12:15], s54 offen offset:2048 sc1 lds
    buffer_load_dwordx4 v15, s[12:15], s54 offen offset:3072 sc1 lds
    v_mov_b32 v10, 0
    s_mov_b64 exec, 1
    buffer_atomic_add v10, v6, s[28:31], s39 offen sc0 sc1
    s_mov_b64 exec, -1
    s_waitcnt vmcnt(10)
    ds_read_b64_tr_b16 a[32:33], v20 offset:8192
    ds_read_b64_tr_b16 a[34:35], v20 offset:9216
    ds_read_b64_tr_b16 a[36:37], v21 offset:8192
    ds_read_b64_tr_b16 a[38:39], v21 offset:9216
    ds_read_b64_tr_b16 a[40:41], v22 offset:8192
    ds_read_b64_tr_b16 a[42:43], v22 offset:9216
    ds_read_b64_tr_b16 a[44:45], v23 offset:8192
    ds_read_b64_tr_b16 a[46:47], v23 offset:9216
    s_waitcnt lgkmcnt(0)
    s_mul_i32 s54, s69, s100
    s_add_u32 m0, s52, 8192
    s_nop 0
    buffer_load_dwordx4 v12, s[12:15], s54 offen offset:0 sc1 lds
    buffer_load_dwordx4 v13, s[12:15], s54 offen offset:1024 sc1 lds
    buffer_load_dwordx4 v14, s[12:15], s54 offen offset:2048 sc1 lds
    buffer_load_dwordx4 v15, s[12:15], s54 offen offset:3072 sc1 lds
    s_waitcnt vmcnt(4)
    v_cmp_gt_u32 vcc, 16, v10
    s_mov_b32 s57, 0
    s_and_b32 vcc_lo, vcc_lo, 1
    s_cbranch_scc1 L_slow_B_24
L_back_B_25:
    buffer_load_dwordx4 v[176:179], v4, s[28:31], s40 offen offset:0 sc1
    buffer_load_dwordx4 v[180:183], v4, s[28:31], s40 offen offset:1024 sc1
    buffer_load_dwordx4 v[184:187], v4, s[28:31], s40 offen offset:2048 sc1
    buffer_load_dwordx4 v[188:191], v4, s[28:31], s40 offen offset:3072 sc1
    s_add_u32 s40, s40, 4096
    buffer_load_dwordx4 v[192:195], v4, s[28:31], s40 offen offset:0 sc1
    buffer_load_dwordx4 v[196:199], v4, s[28:31], s40 offen offset:1024 sc1
    buffer_load_dwordx4 v[200:203], v4, s[28:31], s40 offen offset:2048 sc1
    buffer_load_dwordx4 v[204:207], v4, s[28:31], s40 offen offset:3072 sc1
    ds_read_b64_tr_b16 a[48:49], v20 offset:0
    ds_read_b64_tr_b16 a[50:51], v20 offset:1024
    ds_read_b64_tr_b16 a[52:53], v21 offset:0
    ds_read_b64_tr_b16 a[54:55], v21 offset:1024
    ds_read_b64_tr_b16 a[56:57], v22 offset:0
    ds_read_b64_tr_b16 a[58:59], v22 offset:1024
    ds_read_b64_tr_b16 a[60:61], v23 offset:0
    ds_read_b64_tr_b16 a[62:63], v23 offset:1024
    ds_read_b64_tr_b16 a[64:65], v20 offset:4096
    ds_read_b64_tr_b16 a[66:67], v20 offset:5120
    ds_read_b64_tr_b16 a[68:69], v21 offset:4096
    ds_read_b64_tr_b16 a[70:71], v21 offset:5120
    ds_read_b64_tr_b16 a[72:73], v22 offset:4096
    ds_read_b64_tr_b16 a[74:75], v22 offset:5120
    ds_read_b64_tr_b16 a[76:77], v23 offset:4096
    ds_read_b64_tr_b16 a[78:79], v23 offset:5120
    s_waitcnt vmcnt(8)
    ds_read_b64_tr_b16 a[80:81], v20 offset:8192
    ds_read_b64_tr_b16 a[82:83], v20 offset:9216
    ds_read_b64_tr_b16 a[84:85], v21 offset:8192
    ds_read_b64_tr_b16 a[86:87], v21 offset:9216
    ds_read_b64_tr_b16 a[88:89], v22 offset:8192
    ds_read_b64_tr_b16 a[90:91], v22 offset:9216
    ds_read_b64_tr_b16 a[92:93], v23 offset:8192
    ds_read_b64_tr_b16 a[94:95], v23 offset:9216
    s_waitcnt vmcnt(7)
    v_mfma_f32_16x16x32_bf16 v[36:39], v[176:179], v[56:59], v[36:39]
    v_mfma_f32_16x16x32_bf16 v[40:43], v[176:179], v[60:63], v[40:43]
    s_add_u32 s40, s40, 4096
    buffer_load_dwordx4 v[208:211], v4, s[28:31], s40 offen offset:0 sc1
    v_mfma_f32_16x16x32_bf16 v[44:47], v[176:179], v[64:67], v[44:47]
    v_mfma_f32_16x16x32_bf16 v[48:51], v[176:179], v[68:71], v[48:51]
    buffer_load_dwordx4 v[212:215], v4, s[28:31], s40 offen offset:1024 sc1
    v_mfma_f32_16x16x32_bf16 v[52:55], v[176:179], v[72:75], v[52:55]
    s_waitcnt vmcnt(8)
    v_mfma_f32_16x16x32_bf16 v[36:39], v[180:183], v[76:79], v[36:39]
    buffer_load_dwordx4 v[216:219], v4, s[28:31], s40 offen offset:2048 sc1
    v_mfma_f32_16x16x32_bf16 v[40:43], v[180:183], v[80:83], v[40:43]
    buffer_load_dwordx4 v[220:223], v4, s[28:31], s40 offen offset:3072 sc1
    v_mfma_f32_16x16x32_bf16 v[44:47], v[180:183], v[84:87], v[44:47]
    ds_read_b128 v[56:59], v4 offset:6144
    ds_read_b128 v[60:63], v4 offset:26624
    v_mfma_f32_16x16x32_bf16 v[48:51], v[180:183], v[88:91], v[48:51]
    ds_read_b128 v[64:67], v4 offset:47104
    ds_read_b128 v[68:71], v28 offset:6144
    v_mfma_f32_16x16x32_bf16 v[52:55], v[180:183], v[92:95], v[52:55]
    ds_read_b128 v[72:75], v28 offset:26624
    s_waitcnt vmcnt(9)
    v_mfma_f32_16x16x32_bf16 v[36:39], v[184:187], v[96:99], v[36:39]
    s_add_u32 s40, s40, 4096
    buffer_load_dwordx4 v[224:227], v4, s[28:31], s40 offen offset:0 sc1
    v_mfma_f32_16x16x32_bf16 v[40:43], v[184:187], v[100:103], v[40:43]
    buffer_load_dwordx4 v[228:231], v4, s[28:31], s40 offen offset:1024 sc1
    v_mfma_f32_16x16x32_bf16 v[44:47], v[184:187], v[104:107], v[44:47]
    ds_read_b128 v[76:79], v4 offset:7168
    ds_read_b128 v[80:83], v4 offset:27648
    v_mfma_f32_16x16x32_bf16 v[48:51], v[184:187], v[108:111], v[48:51]
    ds_read_b128 v[84:87], v4 offset:48128
    ds_read_b128 v[88:91], v28 offset:7168
    v_mfma_f32_16x16x32_bf16 v[52:55], v[184:187], v[112:115], v[52:55]
    ds_read_b128 v[92:95], v28 offset:27648
    s_waitcnt vmcnt(10)
    v_mfma_f32_16x16x32_bf16 v[36:39], v[188:191], v[116:119], v[36:39]
    buffer_load_dwordx4 v[232:235], v4, s[28:31], s40 offen offset:2048 sc1
    v_mfma_f32_16x16x32_bf16 v[40:43], v[188:191], v[120:123], v[40:43]
    buffer_load_dwordx4 v[236:239], v4, s[28:31], s40 offen offset:3072 sc1
    v_mfma_f32_16x16x32_bf16 v[44:47], v[188:191], v[124:127], v[44:47]
    ds_read_b128 v[96:99], v4 offset:8192
    ds_read_b128 v[100:103], v4 offset:28672
    v_mfma_f32_16x16x32_bf16 v[48:51], v[188:191], v[128:131], v[48:51]
    ds_read_b128 v[104:107], v4 offset:49152
    ds_read_b128 v[108:111], v28 offset:8192
    v_mfma_f32_16x16x32_bf16 v[52:55], v[188:191], v[132:135], v[52:55]
    ds_read_b128 v[112:115], v28 offset:28672
    s_waitcnt vmcnt(11)
    v_mfma_f32_16x16x32_bf16 v[36:39], v[192:195], v[136:139], v[36:39]
    s_add_u32 s40, s40, 4096
    buffer_load_dwordx4 v[240:243], v4, s[28:31], s40 offen offset:0 sc1
    v_mfma_f32_16x16x32_bf16 v[40:43], v[192:195], v[140:143], v[40:43]
    ds_read_b128 v[116:119], v4 offset:9216
    v_mfma_f32_16x16x32_bf16 v[44:47], v[192:195], v[144:147], v[44:47]
    ds_read_b128 v[120:123], v4 offset:29696
    ds_read_b128 v[124:127], v4 offset:50176
    v_mfma_f32_16x16x32_bf16 v[48:51], v[192:195], v[148:151], v[48:51]
    ds_read_b128 v[128:131], v28 offset:9216
    v_mfma_f32_16x16x32_bf16 v[52:55], v[192:195], v[152:155], v[52:55]
    ds_read_b128 v[132:135], v28 offset:29696
    s_waitcnt vmcnt(11)
    v_mfma_f32_16x16x32_bf16 v[36:39], v[196:199], v[156:159], v[36:39]
    buffer_load_dwordx4 v[244:247], v4, s[28:31], s40 offen offset:1024 sc1
    v_mfma_f32_16x16x32_bf16 v[40:43], v[196:199], v[160:163], v[40:43]
    ds_read_b128 v[136:139], v4 offset:10240
    v_mfma_f32_16x16x32_bf16 v[44:47], v[196:199], v[164:167], v[44:47]
    ds_read_b128 v[140:143], v4 offset:30720
    ds_read_b128 v[144:147], v4 offset:51200
    v_mfma_f32_16x16x32_bf16 v[48:51], v[196:199], v[168:171], v[48:51]
    ds_read_b128 v[148:151], v28 offset:10240
    v_mfma_f32_16x16x32_bf16 v[52:55], v[196:199], v[172:175], v[52:55]
    ds_read_b128 v[152:155], v28 offset:30720
    s_waitcnt vmcnt(11)
    s_waitcnt lgkmcnt(15)
    v_mfma_f32_16x16x32_bf16 v[36:39], v[200:203], v[56:59], v[36:39]
    buffer_load_dwordx4 v[248:251], v4, s[28:31], s40 offen offset:2048 sc1
    v_mfma_f32_16x16x32_bf16 v[40:43], v[200:203], v[60:63], v[40:43]
    ds_read_b128 v[156:159], v4 offset:11264
    v_mfma_f32_16x16x32_bf16 v[44:47], v[200:203], v[64:67], v[44:47]
    ds_read_b128 v[160:163], v4 offset:31744
    ds_read_b128 v[164:167], v4 offset:52224
    v_mfma_f32_16x16x32_bf16 v[48:51], v[200:203], v[68:71], v[48:51]
    ds_read_b128 v[168:171], v28 offset:11264
    v_mfma_f32_16x16x32_bf16 v[52:55], v[200:203], v[72:75], v[52:55]
    ds_read_b128 v[172:175], v28 offset:31744
    s_waitcnt vmcnt(11)
    s_waitcnt lgkmcnt(15)
    v_mfma_f32_16x16x32_bf16 v[36:39], v[204:207], v[76:79], v[36:39]
    buffer_load_dwordx4 v[252:255], v4, s[28:31], s40 offen offset:3072 sc1
    v_mfma_f32_16x16x32_bf16 v[40:43], v[204:207], v[80:83], v[40:43]
    ds_read_b128 v[56:59], v4 offset:12288
    v_mfma_f32_16x16x32_bf16 v[44:47], v[204:207], v[84:87], v[44:47]
    ds_read_b128 v[60:63], v4 offset:32768
    ds_read_b128 v[64:67], v4 offset:53248
    v_mfma_f32_16x16x32_bf16 v[48:51], v[204:207], v[88:91], v[48:51]
    ds_read_b128 v[68:71], v28 offset:12288
    v_mfma_f32_16x16x32_bf16 v[52:55], v[204:207], v[92:95], v[52:55]
    ds_read_b128 v[72:75], v28 offset:32768
    s_waitcnt vmcnt(11)
    s_waitcnt lgkmcnt(15)
    v_mfma_f32_16x16x32_bf16 v[36:39], v[208:211], v[96:99], v[36:39]
    s_mul_i32 s54, s70, s100
    s_add_u32 m0, s52, 0
    s_nop 0
    buffer_load_dwordx4 v12, s[12:15], s54 offen offset:0 sc1 lds
    v_mfma_f32_16x16x32_bf16 v[40:43], v[208:211], v[100:103], v[40:43]
    ds_read_b128 v[76:79], v4 offset:13312
    v_mfma_f32_16x16x32_bf16 v[44:47], v[208:211], v[104:107], v[44:47]
    ds_read_b128 v[80:83], v4 offset:33792
    ds_read_b128 v[84:87], v4 offset:54272
    v_mfma_f32_16x16x32_bf16 v[48:51], v[208:211], v[108:111], v[48:51]
    ds_read_b128 v[88:91], v28 offset:13312
    v_mfma_f32_16x16x32_bf16 v[52:55], v[208:211], v[112:115], v[52:55]
    ds_read_b128 v[92:95], v28 offset:33792
    s_waitcnt vmcnt(11)
    s_waitcnt lgkmcnt(15)
    v_mfma_f32_16x16x32_bf16 v[36:39], v[212:215], v[116:119], v[36:39]
    buffer_load_dwordx4 v13, s[12:15], s54 offen offset:1024 sc1 lds
    v_mfma_f32_16x16x32_bf16 v[40:43], v[212:215], v[120:123], v[40:43]
    ds_read_b128 v[96:99], v4 offset:14336
    v_mfma_f32_16x16x32_bf16 v[44:47], v[212:215], v[124:127], v[44:47]
    ds_read_b128 v[100:103], v4 offset:34816
    ds_read_b128 v[104:107], v4 offset:55296
    v_mfma_f32_16x16x32_bf16 v[48:51], v[212:215], v[128:131], v[48:51]
    ds_read_b128 v[108:111], v28 offset:14336
    v_mfma_f32_16x16x32_bf16 v[52:55], v[212:215], v[132:135], v[52:55]
    ds_read_b128 v[112:115], v28 offset:34816
    s_waitcnt vmcnt(11)
    s_waitcnt lgkmcnt(15)
    v_mfma_f32_16x16x32_bf16 v[36:39], v[216:219], v[136:139], v[36:39]
    buffer_load_dwordx4 v14, s[12:15], s54 offen offset:2048 sc1 lds
    v_mfma_f32_16x16x32_bf16 v[40:43], v[216:219], v[140:143], v[40:43]
    ds_read_b128 v[116:119], v4 offset:15360
    v_mfma_f32_16x16x32_bf16 v[44:47], v[216:219], v[144:147], v[44:47]
    ds_read_b128 v[120:123], v4 offset:35840
    ds_read_b128 v[124:127], v4 offset:56320
    v_mfma_f32_16x16x32_bf16 v[48:51], v[216:219], v[148:151], v[48:51]
    ds_read_b128 v[128:131], v28 offset:15360
    v_mfma_f32_16x16x32_bf16 v[52:55], v[216:219], v[152:155], v[52:55]
    ds_read_b128 v[132:135], v28 offset:35840
    s_waitcnt vmcnt(11)
    s_waitcnt lgkmcnt(15)
    v_mfma_f32_16x16x32_bf16 v[36:39], v[220:223], v[156:159], v[36:39]
    buffer_load_dwordx4 v15, s[12:15], s54 offen offset:3072 sc1 lds
    v_mfma_f32_16x16x32_bf16 v[40:43], v[220:223], v[160:163], v[40:43]
    ds_read_b128 v[136:139], v4 offset:16384
    v_mfma_f32_16x16x32_bf16 v[44:47], v[220:223], v[164:167], v[44:47]
    ds_read_b128 v[140:143], v4 offset:36864
    ds_read_b128 v[144:147], v4 offset:57344
    v_mfma_f32_16x16x32_bf16 v[48:51], v[220:223], v[168:171], v[48:51]
    ds_read_b128 v[148:151], v28 offset:16384
    v_mfma_f32_16x16x32_bf16 v[52:55], v[220:223], v[172:175], v[52:55]
    ds_read_b128 v[152:155], v28 offset:36864
    s_waitcnt vmcnt(11)
    s_waitcnt lgkmcnt(15)
    v_mfma_f32_16x16x32_bf16 v[36:39], v[224:227], v[56:59], v[36:39]
    s_mul_i32 s54, s71, s100
    s_add_u32 m0, s52, 4096
    s_nop 0
    buffer_load_dwordx4 v12, s[12:15], s54 offen offset:0 sc1 lds
    v_mfma_f32_16x16x32_bf16 v[40:43], v[224:227], v[60:63], v[40:43]
    ds_read_b128 v[156:159], v4 offset:17408
    v_mfma_f32_16x16x32_bf16 v[44:47], v[224:227], v[64:67], v[44:47]
    ds_read_b128 v[160:163], v4 offset:37888
    ds_read_b128 v[164:167], v4 offset:58368
    v_mfma_f32_16x16x32_bf16 v[48:51], v[224:227], v[68:71], v[48:51]
    ds_read_b128 v[168:171], v28 offset:17408
    v_mfma_f32_16x16x32_bf16 v[52:55], v[224:227], v[72:75], v[52:55]
    ds_read_b128 v[172:175], v28 offset:37888
    s_waitcnt vmcnt(11)
    s_waitcnt lgkmcnt(15)
    v_mfma_f32_16x16x32_bf16 v[36:39], v[228:231], v[76:79], v[36:39]
    buffer_load_dwordx4 v13, s[12:15], s54 offen offset:1024 sc1 lds
    v_mfma_f32_16x16x32_bf16 v[40:43], v[228:231], v[80:83], v[40:43]
    ds_read_b128 v[56:59], v4 offset:18432
    v_mfma_f32_16x16x32_bf16 v[44:47], v[228:231], v[84:87], v[44:47]
    ds_read_b128 v[60:63], v4 offset:38912
    ds_read_b128 v[64:67], v4 offset:59392
    v_mfma_f32_16x16x32_bf16 v[48:51], v[228:231], v[88:91], v[48:51]
    ds_read_b128 v[68:71], v28 offset:18432
    v_mfma_f32_16x16x32_bf16 v[52:55], v[228:231], v[92:95], v[52:55]
    ds_read_b128 v[72:75], v28 offset:38912
    s_waitcnt vmcnt(11)
    s_waitcnt lgkmcnt(15)
    v_mfma_f32_16x16x32_bf16 v[36:39], v[232:235], v[96:99], v[36:39]
    buffer_load_dwordx4 v14, s[12:15], s54 offen offset:2048 sc1 lds
    v_mfma_f32_16x16x32_bf16 v[40:43], v[232:235], v[100:103], v[40:43]
    ds_read_b128 v[76:79], v4 offset:19456
    v_mfma_f32_16x16x32_bf16 v[44:47], v[232:235], v[104:107], v[44:47]
    ds_read_b128 v[80:83], v4 offset:39936
    ds_read_b128 v[84:87], v4 offset:60416
    v_mfma_f32_16x16x32_bf16 v[48:51], v[232:235], v[108:111], v[48:51]
    ds_read_b128 v[88:91], v28 offset:19456
    v_mfma_f32_16x16x32_bf16 v[52:55], v[232:235], v[112:115], v[52:55]
    ds_read_b128 v[92:95], v28 offset:39936
    s_waitcnt vmcnt(11)
    s_waitcnt lgkmcnt(15)
    v_mfma_f32_16x16x32_bf16 v[36:39], v[236:239], v[116:119], v[36:39]
    v_mfma_f32_16x16x32_bf16 v[40:43], v[236:239], v[120:123], v[40:43]
    v_mfma_f32_16x16x32_bf16 v[44:47], v[236:239], v[124:127], v[44:47]
    buffer_load_dwordx4 v15, s[12:15], s54 offen offset:3072 sc1 lds
    v_mfma_f32_16x16x32_bf16 v[48:51], v[236:239], v[128:131], v[48:51]
    v_mfma_f32_16x16x32_bf16 v[52:55], v[236:239], v[132:135], v[52:55]
    s_waitcnt vmcnt(11)
    s_waitcnt lgkmcnt(15)
    v_mfma_f32_16x16x32_bf16 v[36:39], v[240:243], v[136:139], v[36:39]
    v_mfma_f32_16x16x32_bf16 v[40:43], v[240:243], v[140:143], v[40:43]
    v_mfma_f32_16x16x32_bf16 v[44:47], v[240:243], v[144:147], v[44:47]
    s_mul_i32 s54, s72, s100
    s_add_u32 m0, s52, 8192
    s_nop 0
    buffer_load_dwordx4 v12, s[12:15], s54 offen offset:0 sc1 lds
    v_mfma_f32_16x16x32_bf16 v[48:51], v[240:243], v[148:151], v[48:51]
    v_mfma_f32_16x16x32_bf16 v[52:55], v[240:243], v[152:155], v[52:55]
    s_waitcnt vmcnt(11)
    s_waitcnt lgkmcnt(10)
    v_mfma_f32_16x16x32_bf16 v[36:39], v[244:247], v[156:159], v[36:39]
    v_mfma_f32_16x16x32_bf16 v[40:43], v[244:247], v[160:163], v[40:43]
    v_mfma_f32_16x16x32_bf16 v[44:47], v[244:247], v[164:167], v[44:47]
    buffer_load_dwordx4 v13, s[12:15], s54 offen offset:1024 sc1 lds
    v_mfma_f32_16x16x32_bf16 v[48:51], v[244:247], v[168:171], v[48:51]
    v_mfma_f32_16x16x32_bf16 v[52:55], v[244:247], v[172:175], v[52:55]
    s_waitcnt vmcnt(11)
    s_waitcnt lgkmcnt(5)
    v_mfma_f32_16x16x32_bf16 v[36:39], v[248:251], v[56:59], v[36:39]
    v_mfma_f32_16x16x32_bf16 v[40:43], v[248:251], v[60:63], v[40:43]
    v_mfma_f32_16x16x32_bf16 v[44:47], v[248:251], v[64:67], v[44:47]
    buffer_load_dwordx4 v14, s[12:15], s54 offen offset:2048 sc1 lds
    v_mfma_f32_16x16x32_bf16 v[48:51], v[248:251], v[68:71], v[48:51]
    v_mfma_f32_16x16x32_bf16 v[52:55], v[248:251], v[72:75], v[52:55]
    s_waitcnt vmcnt(11)
    s_waitcnt lgkmcnt(0)
    v_mfma_f32_16x16x32_bf16 v[36:39], v[252:255], v[76:79], v[36:39]
    v_mfma_f32_16x16x32_bf16 v[40:43], v[252:255], v[80:83], v[40:43]
    v_mfma_f32_16x16x32_bf16 v[44:47], v[252:255], v[84:87], v[44:47]
    buffer_load_dwordx4 v15, s[12:15], s54 offen offset:3072 sc1 lds
    v_mfma_f32_16x16x32_bf16 v[48:51], v[252:255], v[88:91], v[48:51]
    v_mfma_f32_16x16x32_bf16 v[52:55], v[252:255], v[92:95], v[52:55]
    s_lshl_b32 s50, s92, 10
    s_add_u32 s50, s50, 196608
    s_lshl_b32 s47, s42, 7
    s_add_u32 s47, s47, s50
    v_pk_add_f32 v[56:57], v[36:37], v[40:41]
    v_pk_mul_f32 v[60:61], v[36:37], v[36:37]
    v_pk_add_f32 v[58:59], v[38:39], v[42:43]
    v_pk_mul_f32 v[62:63], v[38:39], v[38:39]
    v_pk_fma_f32 v[60:61], v[40:41], v[40:41], v[60:61]
    v_pk_fma_f32 v[62:63], v[42:43], v[42:43], v[62:63]
    v_pk_add_f32 v[56:57], v[56:57], v[44:45]
    v_pk_fma_f32 v[60:61], v[44:45], v[44:45], v[60:61]
    v_pk_add_f32 v[58:59], v[58:59], v[46:47]
    v_pk_fma_f32 v[62:63], v[46:47], v[46:47], v[62:63]
    v_pk_add_f32 v[56:57], v[56:57], v[48:49]
    v_pk_fma_f32 v[60:61], v[48:49], v[48:49], v[60:61]
    v_pk_add_f32 v[58:59], v[58:59], v[50:51]
    v_pk_fma_f32 v[62:63], v[50:51], v[50:51], v[62:63]
    v_pk_add_f32 v[56:57], v[56:57], v[52:53]
    v_pk_fma_f32 v[60:61], v[52:53], v[52:53], v[60:61]
    v_pk_add_f32 v[58:59], v[58:59], v[54:55]
    v_pk_fma_f32 v[62:63], v[54:55], v[54:55], v[62:63]
    v_add_f32_dpp v56, v56, v56 row_ror:8 row_mask:0xf bank_mask:0xf
    v_add_f32_dpp v57, v57, v57 row_ror:8 row_mask:0xf bank_mask:0xf
    v_add_f32_dpp v58, v58, v58 row_ror:8 row_mask:0xf bank_mask:0xf
    v_add_f32_dpp v59, v59, v59 row_ror:8 row_mask:0xf bank_mask:0xf
    v_add_f32_dpp v60, v60, v60 row_ror:8 row_mask:0xf bank_mask:0xf
    v_add_f32_dpp v61, v61, v61 row_ror:8 row_mask:0xf bank_mask:0xf
    v_add_f32_dpp v62, v62, v62 row_ror:8 row_mask:0xf bank_mask:0xf
    v_add_f32_dpp v63, v63, v63 row_ror:8 row_mask:0xf bank_mask:0xf
    v_cndmask_b32 v64, v56, v58, s[60:61]
    v_cndmask_b32 v65, v60, v62, s[60:61]
    v_cndmask_b32 v66, v57, v59, s[60:61]
    v_cndmask_b32 v67, v61, v63, s[60:61]
    v_add_f32_dpp v64, v64, v64 quad_perm:[1,0,3,2] row_mask:0xf bank_mask:0xf
    v_add_f32_dpp v65, v65, v65 quad_perm:[1,0,3,2] row_mask:0xf bank_mask:0xf
    v_add_f32_dpp v66, v66, v66 quad_perm:[1,0,3,2] row_mask:0xf bank_mask:0xf
    v_add_f32_dpp v67, v67, v67 quad_perm:[1,0,3,2] row_mask:0xf bank_mask:0xf
    v_add_f32_dpp v64, v64, v64 quad_perm:[2,3,0,1] row_mask:0xf bank_mask:0xf
    v_add_f32_dpp v65, v65, v65 quad_perm:[2,3,0,1] row_mask:0xf bank_mask:0xf
    v_add_f32_dpp v66, v66, v66 quad_perm:[2,3,0,1] row_mask:0xf bank_mask:0xf
    v_add_f32_dpp v67, v67, v67 quad_perm:[2,3,0,1] row_mask:0xf bank_mask:0xf
    v_add_f32_dpp v64, v64, v64 row_half_mirror row_mask:0xf bank_mask:0xf
    v_add_f32_dpp v65, v65, v65 row_half_mirror row_mask:0xf bank_mask:0xf
    v_add_f32_dpp v66, v66, v66 row_half_mirror row_mask:0xf bank_mask:0xf
    v_add_f32_dpp v67, v67, v67 row_half_mirror row_mask:0xf bank_mask:0xf
    s_mov_b32 exec_lo, 0x01010101
    s_mov_b32 exec_hi, 0x01010101
    buffer_store_dwordx4 v[64:67], v33, s[28:31], s47 offen sc1
    s_mov_b64 exec, -1
    s_barrier
    s_mul_i32 s54, s73, s100
    s_add_u32 m0, s55, 0
    s_nop 0
    buffer_load_dwordx4 v12, s[12:15], s54 offen offset:0 sc1 lds
    buffer_load_dwordx4 v13, s[12:15], s54 offen offset:1024 sc1 lds
    buffer_load_dwordx4 v14, s[12:15], s54 offen offset:2048 sc1 lds
    buffer_load_dwordx4 v15, s[12:15], s54 offen offset:3072 sc1 lds
    s_mul_i32 s54, s74, s100
    s_add_u32 m0, s55, 4096
    s_nop 0
    buffer_load_dwordx4 v12, s[12:15], s54 offen offset:0 sc1 lds
    buffer_load_dwordx4 v13, s[12:15], s54 offen offset:1024 sc1 lds
    buffer_load_dwordx4 v14, s[12:15], s54 offen offset:2048 sc1 lds
    buffer_load_dwordx4 v15, s[12:15], s54 offen offset:3072 sc1 lds
    v_cvt_pk_bf16_f32 v100, v36, v37
    v_cvt_pk_bf16_f32 v101, v38, v39
    v_cvt_pk_bf16_f32 v102, v40, v41
    v_cvt_pk_bf16_f32 v103, v42, v43
    v_cvt_pk_bf16_f32 v104, v44, v45
    v_cvt_pk_bf16_f32 v105, v46, v47
    v_cvt_pk_bf16_f32 v106, v48, v49
    v_cvt_pk_bf16_f32 v107, v50, v51
    v_cvt_pk_bf16_f32 v108, v52, v53
    v_cvt_pk_bf16_f32 v109, v54, v55
    s_mul_i32 s32, s42, 327680
    s_lshl_b32 s47, s92, 9
    s_add_u32 s32, s32, s47
    s_add_u32 s32, s32, 5242880
    s_add_u32 s33, s32, 131072
    s_add_u32 s34, s32, 262144
    s_lshr_b32 s47, s41, 3
    s_lshl2_add_u32 s35, s42, s47
    s_lshl_b32 s35, s35, 7
    s_add_u32 s35, s35, 36864
    s_mov_b32 s97, 0x3acccccd
    s_mov_b32 s3, 0x3727c5ac
    s_waitcnt vmcnt(17)
    ds_read_b64_tr_b16 a[96:97], v20 offset:0
    ds_read_b64_tr_b16 a[98:99], v20 offset:1024
    ds_read_b64_tr_b16 a[100:101], v21 offset:0
    ds_read_b64_tr_b16 a[102:103], v21 offset:1024
    ds_read_b64_tr_b16 a[104:105], v22 offset:0
    ds_read_b64_tr_b16 a[106:107], v22 offset:1024
    ds_read_b64_tr_b16 a[108:109], v23 offset:0
    ds_read_b64_tr_b16 a[110:111], v23 offset:1024
    s_waitcnt vmcnt(13)
    ds_read_b64_tr_b16 a[112:113], v20 offset:4096
    ds_read_b64_tr_b16 a[114:115], v20 offset:5120
    ds_read_b64_tr_b16 a[116:117], v21 offset:4096
    ds_read_b64_tr_b16 a[118:119], v21 offset:5120
    ds_read_b64_tr_b16 a[120:121], v22 offset:4096
    ds_read_b64_tr_b16 a[122:123], v22 offset:5120
    ds_read_b64_tr_b16 a[124:125], v23 offset:4096
    ds_read_b64_tr_b16 a[126:127], v23 offset:5120
    buffer_load_dwordx4 v[68:71], v34, s[28:31], s50 offen sc1
    s_mul_i32 s54, s75, s100
    s_add_u32 m0, s55, 8192
    s_nop 0
    buffer_load_dwordx4 v12, s[12:15], s54 offen offset:0 sc1 lds
    buffer_load_dwordx4 v13, s[12:15], s54 offen offset:1024 sc1 lds
    buffer_load_dwordx4 v14, s[12:15], s54 offen offset:2048 sc1 lds
    buffer_load_dwordx4 v15, s[12:15], s54 offen offset:3072 sc1 lds
    s_mul_i32 s54, s76, s100
    s_add_u32 m0, s55, 12288
    s_nop 0
    buffer_load_dwordx4 v12, s[12:15], s54 offen offset:0 sc1 lds
    buffer_load_dwordx4 v13, s[12:15], s54 offen offset:1024 sc1 lds
    buffer_load_dwordx4 v14, s[12:15], s54 offen offset:2048 sc1 lds
    buffer_load_dwordx4 v15, s[12:15], s54 offen offset:3072 sc1 lds
    v_accvgpr_read_b32 v122, a252
    v_accvgpr_read_b32 v123, a253
    v_accvgpr_read_b32 v124, a254
    s_add_u32 s46, s38, 0
    s_and_b32 s46, s46, 3
    s_mul_i32 s47, s46, 3072
    s_add_u32 s47, s47, 81920
    v_add_u32 v113, s47, v4
    s_add_u32 s46, s38, 1
    s_and_b32 s46, s46, 3
    s_mul_i32 s47, s46, 3072
    s_add_u32 s47, s47, 81920
    v_add_u32 v110, s47, v4
    s_add_u32 s46, s38, 2
    s_and_b32 s46, s46, 3
    s_mul_i32 s47, s46, 3072
    s_add_u32 s47, s47, 82944
    v_add_u32 v111, s47, v4
    s_add_u32 s46, s38, 3
    s_and_b32 s46, s46, 3
    s_mul_i32 s47, s46, 3072
    s_add_u32 s47, s47, 83968
    v_add_u32 v112, s47, v4
    v_lshlrev_b32 v120, 16, v122
    v_and_b32 v121, 0xffff0000, v122
    v_lshlrev_b32 v122, 16, v123
    v_and_b32 v123, 0xffff0000, v123
    v_lshlrev_b32 v127, 16, v124
    v_lshlrev_b32 v126, 16, v124
    v_lshlrev_b32 v125, 16, v124
    v_lshlrev_b32 v124, 16, v124
    s_mov_b32 s58, 0xbdd2d3e8
    v_mov_b32 v130, 0xc0135761
    s_waitcnt vmcnt(8)
    v_max_u32 v9, v68, v69
    v_max3_u32 v9, v9, v70, v71
    v_cmp_eq_u32 vcc, -1, v9
    s_mov_b32 s57, 0
    s_cbranch_vccnz L_slow_C_26
L_back_C_27:
    s_mul_i32 s54, s77, s100
    s_add_u32 m0, s55, 16384
    s_nop 0
    buffer_load_dwordx4 v12, s[12:15], s54 offen offset:0 sc1 lds
    buffer_load_dwordx4 v13, s[12:15], s54 offen offset:1024 sc1 lds
    buffer_load_dwordx4 v14, s[12:15], s54 offen offset:2048 sc1 lds
    buffer_load_dwordx4 v15, s[12:15], s54 offen offset:3072 sc1 lds
    v_add_f32_dpp v68, v68, v68 quad_perm:[1,0,3,2] row_mask:0xf bank_mask:0xf
    v_add_f32_dpp v69, v69, v69 quad_perm:[1,0,3,2] row_mask:0xf bank_mask:0xf
    v_add_f32_dpp v70, v70, v70 quad_perm:[1,0,3,2] row_mask:0xf bank_mask:0xf
    v_add_f32_dpp v71, v71, v71 quad_perm:[1,0,3,2] row_mask:0xf bank_mask:0xf
    v_add_f32_dpp v68, v68, v68 quad_perm:[2,3,0,1] row_mask:0xf bank_mask:0xf
    v_add_f32_dpp v69, v69, v69 quad_perm:[2,3,0,1] row_mask:0xf bank_mask:0xf
    v_add_f32_dpp v70, v70, v70 quad_perm:[2,3,0,1] row_mask:0xf bank_mask:0xf
    v_add_f32_dpp v71, v71, v71 quad_perm:[2,3,0,1] row_mask:0xf bank_mask:0xf
    v_add_f32_dpp v68, v68, v68 row_half_mirror row_mask:0xf bank_mask:0xf
    v_add_f32_dpp v69, v69, v69 row_half_mirror row_mask:0xf bank_mask:0xf
    v_add_f32_dpp v70, v70, v70 row_half_mirror row_mask:0xf bank_mask:0xf
    v_add_f32_dpp v71, v71, v71 row_half_mirror row_mask:0xf bank_mask:0xf
    v_mul_f32 v68, s97, v68
    v_mul_f32 v70, s97, v70
    v_mul_f32 v64, v68, v68
    v_mul_f32 v66, v70, v70
    v_fma_f32 v69, v69, s97, -v64
    v_fma_f32 v71, v71, s97, -v66
    v_max_f32 v69, 0, v69
    v_max_f32 v71, 0, v71
    v_add_f32 v64, s3, v69
    v_add_f32 v66, s3, v71
    v_rsq_f32 v64, v64
    v_rsq_f32 v66, v66
    v_mul_f32 v69, v69, v64
    v_mul_f32 v71, v71, v66
    v_fma_f32 v69, v69, v64, s3
    v_fma_f32 v71, v71, v66, s3
    v_rsq_f32 v69, v69
    v_rsq_f32 v71, v71
    v_mul_f32 v69, v69, v64
    v_mul_f32 v71, v71, v66
    v_mul_f32 v68, -v68, v69
    v_mul_f32 v70, -v70, v71
    s_nop 0
    v_mov_b32_dpp v64, v68 row_ror:8 row_mask:0xf bank_mask:0xf
    v_mov_b32_dpp v65, v69 row_ror:8 row_mask:0xf bank_mask:0xf
    v_mov_b32_dpp v66, v70 row_ror:8 row_mask:0xf bank_mask:0xf
    v_mov_b32_dpp v67, v71 row_ror:8 row_mask:0xf bank_mask:0xf
    v_cndmask_b32 v56, v68, v64, s[60:61]
    v_cndmask_b32 v58, v64, v68, s[60:61]
    v_cndmask_b32 v60, v69, v65, s[60:61]
    v_cndmask_b32 v62, v65, v69, s[60:61]
    v_cndmask_b32 v57, v70, v66, s[60:61]
    v_cndmask_b32 v59, v66, v70, s[60:61]
    v_cndmask_b32 v61, v71, v67, s[60:61]
    v_cndmask_b32 v63, v67, v71, s[60:61]
    v_pk_fma_f32 v[36:37], v[36:37], v[60:61], v[56:57]
    v_pk_fma_f32 v[38:39], v[38:39], v[62:63], v[58:59]
    v_cvt_pk_bf16_f32 v72, v36, v37
    v_cvt_pk_bf16_f32 v73, v38, v39
    v_pk_fma_f32 v[40:41], v[40:41], v[60:61], v[56:57]
    v_pk_fma_f32 v[42:43], v[42:43], v[62:63], v[58:59]
    v_cvt_pk_bf16_f32 v74, v40, v41
    v_cvt_pk_bf16_f32 v75, v42, v43
    s_nop 0
    v_permlane32_swap_b32 v72, v74
    v_permlane32_swap_b32 v73, v75
    buffer_store_dwordx4 v[72:75], v35, s[28:31], s32 offen sc1
    v_pk_fma_f32 v[44:45], v[44:45], v[60:61], v[56:57]
    v_pk_fma_f32 v[46:47], v[46:47], v[62:63], v[58:59]
    v_cvt_pk_bf16_f32 v76, v44, v45
    v_cvt_pk_bf16_f32 v77, v46, v47
    v_pk_fma_f32 v[48:49], v[48:49], v[60:61], v[56:57]
    v_pk_fma_f32 v[50:51], v[50:51], v[62:63], v[58:59]
    v_cvt_pk_bf16_f32 v78, v48, v49
    v_cvt_pk_bf16_f32 v79, v50, v51
    s_nop 0
    v_permlane32_swap_b32 v76, v78
    v_permlane32_swap_b32 v77, v79
    buffer_store_dwordx4 v[76:79], v35, s[28:31], s33 offen sc1
    v_pk_fma_f32 v[52:53], v[52:53], v[60:61], v[56:57]
    v_pk_fma_f32 v[54:55], v[54:55], v[62:63], v[58:59]
    v_cvt_pk_bf16_f32 v80, v52, v53
    v_cvt_pk_bf16_f32 v81, v54, v55
    v_mov_b32 v82, v80
    v_mov_b32 v83, v81
    s_nop 0
    v_permlane32_swap_b32 v80, v82
    v_permlane32_swap_b32 v81, v83
    s_mov_b32 exec_hi, 0
    buffer_store_dwordx4 v[80:83], v35, s[28:31], s34 offen sc1
    s_mov_b32 exec_hi, -1
    s_waitcnt lgkmcnt(8)
    s_mul_i32 s54, s78, s100
    s_add_u32 m0, s52, 0
    s_nop 0
    buffer_load_dwordx4 v12, s[12:15], s54 offen offset:0 sc1 lds
    buffer_load_dwordx4 v13, s[12:15], s54 offen offset:1024 sc1 lds
    buffer_load_dwordx4 v14, s[12:15], s54 offen offset:2048 sc1 lds
    buffer_load_dwordx4 v15, s[12:15], s54 offen offset:3072 sc1 lds
    s_waitcnt lgkmcnt(0)
    s_mul_i32 s54, s79, s100
    s_add_u32 m0, s52, 4096
    s_nop 0
    buffer_load_dwordx4 v12, s[12:15], s54 offen offset:0 sc1 lds
    buffer_load_dwordx4 v13, s[12:15], s54 offen offset:1024 sc1 lds
    buffer_load_dwordx4 v14, s[12:15], s54 offen offset:2048 sc1 lds
    buffer_load_dwordx4 v15, s[12:15], s54 offen offset:3072 sc1 lds
    s_lshl_b32 s46, s43, 2
    v_and_b32 v116, 1, v1
    v_mul_u32_u24 v116, 3, v116
    v_add_u32 v116, s46, v116
    v_mul_u32_u24 v116, 52, v116
    v_lshrrev_b32 v116, 8, v116
    v_lshlrev_b32 v116, 9, v116
    s_cmp_ge_u32 s43, 5
    s_cselect_b32 s48, 5, 0
    s_sub_u32 s48, s43, s48
    s_add_u32 s88, s48, 0
    s_and_b32 s88, s88, 3
    s_add_u32 s88, s88, s46
    s_add_u32 s89, s48, 1
    s_and_b32 s89, s89, 3
    s_add_u32 s89, s89, s46
    s_add_u32 s90, s48, 2
    s_and_b32 s90, s90, 3
    s_add_u32 s90, s90, s46
    s_add_u32 s91, s48, 3
    s_and_b32 s91, s91, 3
    s_add_u32 s91, s91, s46
    s_lshl_b32 s47, s38, 14
    s_add_u32 s47, s47, 5242880
    s_lshl2_add_u32 s49, s44, s38
    s_lshl_b32 s49, s49, 9
    s_add_u32 s49, s49, 8388608
    s_lshr_b32 s51, s41, 3
    s_lshl_b32 s51, s51, 7
    s_add_u32 s51, s51, 53248
    s_lshl_b32 s82, s88, 16
    s_add_u32 s82, s82, s47
    s_mul_i32 s86, s88, 49152
    s_add_u32 s86, s86, s49
    s_lshl_b32 s88, s88, 9
    s_add_u32 s88, s88, s51
    s_lshl_b32 s83, s89, 16
    s_add_u32 s83, s83, s47
    s_mul_i32 s87, s89, 49152
    s_add_u32 s87, s87, s49
    s_lshl_b32 s89, s89, 9
    s_add_u32 s89, s89, s51
    s_lshl_b32 s84, s90, 16
    s_add_u32 s84, s84, s47
    s_mul_i32 s98, s90, 49152
    s_add_u32 s98, s98, s49
    s_lshl_b32 s90, s90, 9
    s_add_u32 s90, s90, s51
    s_lshl_b32 s85, s91, 16
    s_add_u32 s85, s85, s47
    s_mul_i32 s99, s91, 49152
    s_add_u32 s99, s99, s49
    s_lshl_b32 s91, s91, 9
    s_add_u32 s91, s91, s51
    s_cmp_ge_u32 s45, 30
    s_cselect_b32 s99, 0x2000000, s99
    s_cselect_b32 s90, 0x2000000, s90
    s_cselect_b32 s91, 0x2000000, s91
    s_lshr_b32 s46, s41, 3
    s_lshl_b32 s46, s46, 5
    s_add_u32 s46, s46, s38
    s_lshl_b32 s36, s46, 7
    s_add_u32 s36, s36, 36864
    v_lshlrev_b32 v136, 12, v1
    v_mul_u32_u24 v137, 20480, v1
    v_lshlrev_b32 v7, 2, v2
    v_sub_u32 v7, v3, v7
    v_mov_b32 v8, 0x3f80
    v_mov_b32 v10, 0x3f800000
    v_cmp_eq_u32 vcc, 0, v7
    v_cmp_eq_u32 s[62:63], 1, v7
    s_nop 0
    v_cndmask_b32 v128, 0, v8, vcc
    v_cndmask_b32 v128, v128, v10, s[62:63]
    v_cmp_eq_u32 vcc, 2, v7
    v_cmp_eq_u32 s[62:63], 3, v7
    s_nop 0
    v_cndmask_b32 v129, 0, v8, vcc
    v_cndmask_b32 v129, v129, v10, s[62:63]
    v_mul_u32_u24 v115, 1280, v3
    v_lshl_add_u32 v115, v2, 3, v115
    s_mul_i32 s46, s92, 20480
    s_mul_i32 s47, s42, 160
    s_add_u32 s46, s46, s47
    v_add_u32 v115, s46, v115
    v_mul_u32_u24 v141, 144, v3
    v_lshl_add_u32 v141, v2, 3, v141
    v_add_u32 v141, s52, v141
    v_lshrrev_b32 v7, 3, v1
    v_lshl_add_u32 v142, v7, 4, v4
    v_add_u32 v142, s52, v142
    v_mul_u32_u24 v7, 1152, v7
    v_add3_u32 v143, v7, v4, s46
    s_movk_i32 s53, 10240
    v_lshlrev_b32 v117, 9, v1
    s_mul_i32 s46, s42, 2560
    s_lshl_b32 s47, s38, 7
    s_add_u32 s46, s46, s47
    s_lshr_b32 s47, s41, 3
    s_mul_i32 s47, s47, 20480
    s_add_u32 s46, s46, s47
    s_add_u32 s37, s46, 53248
    s_mul_i32 s48, s42, 245760
    s_mul_i32 s47, s38, 12288
    s_add_u32 s48, s48, s47
    s_add_u32 s48, s48, 8388608
    v_add_u32 v131, s48, v4
    ds_read_b64_tr_b16 a[128:129], v20 offset:8192
    ds_read_b64_tr_b16 a[130:131], v20 offset:9216
    ds_read_b64_tr_b16 a[132:133], v21 offset:8192
    ds_read_b64_tr_b16 a[134:135], v21 offset:9216
    ds_read_b64_tr_b16 a[136:137], v22 offset:8192
    ds_read_b64_tr_b16 a[138:139], v22 offset:9216
    ds_read_b64_tr_b16 a[140:141], v23 offset:8192
    ds_read_b64_tr_b16 a[142:143], v23 offset:9216
    ds_read_b64_tr_b16 a[144:145], v24 offset:0
    ds_read_b64_tr_b16 a[146:147], v24 offset:1024
    ds_read_b64_tr_b16 a[148:149], v25 offset:0
    ds_read_b64_tr_b16 a[150:151], v25 offset:1024
    ds_read_b64_tr_b16 a[152:153], v26 offset:0
    ds_read_b64_tr_b16 a[154:155], v26 offset:1024
    ds_read_b64_tr_b16 a[156:157], v27 offset:0
    ds_read_b64_tr_b16 a[158:159], v27 offset:1024
    s_waitcnt vmcnt(8)
    s_barrier
    s_cmp_eq_u32 s38, 0
    s_cselect_b64 exec, 15, 0
    buffer_atomic_add v5, v136, s[28:31], s35 offen sc1
    s_mov_b64 exec, -1
    s_waitcnt lgkmcnt(8)
    s_mul_i32 s54, s4, s101
    s_add_u32 m0, s52, 8192
    s_nop 0
    buffer_load_dwordx4 v16, s[16:19], s54 offen offset:0 sc1 lds
    buffer_load_dwordx4 v17, s[16:19], s54 offen offset:1024 sc1 lds
    buffer_load_dwordx4 v18, s[16:19], s54 offen offset:2048 sc1 lds
    buffer_load_dwordx4 v19, s[16:19], s54 offen offset:3072 sc1 lds
    s_waitcnt lgkmcnt(0)
    s_mul_i32 s54, s5, s101
    s_add_u32 m0, s55, 0
    s_nop 0
    buffer_load_dwordx4 v16, s[16:19], s54 offen offset:0 sc1 lds
    buffer_load_dwordx4 v17, s[16:19], s54 offen offset:1024 sc1 lds
    buffer_load_dwordx4 v18, s[16:19], s54 offen offset:2048 sc1 lds
    buffer_load_dwordx4 v19, s[16:19], s54 offen offset:3072 sc1 lds
    ds_read_b64_tr_b16 a[160:161], v24 offset:4096
    ds_read_b64_tr_b16 a[162:163], v24 offset:5120
    ds_read_b64_tr_b16 a[164:165], v25 offset:4096
    ds_read_b64_tr_b16 a[166:167], v25 offset:5120
    ds_read_b64_tr_b16 a[168:169], v26 offset:4096
    ds_read_b64_tr_b16 a[170:171], v26 offset:5120
    ds_read_b64_tr_b16 a[172:173], v27 offset:4096
    ds_read_b64_tr_b16 a[174:175], v27 offset:5120
    ds_read_b64_tr_b16 a[176:177], v24 offset:8192
    ds_read_b64_tr_b16 a[178:179], v24 offset:9216
    ds_read_b64_tr_b16 a[180:181], v25 offset:8192
    ds_read_b64_tr_b16 a[182:183], v25 offset:9216
    ds_read_b64_tr_b16 a[184:185], v26 offset:8192
    ds_read_b64_tr_b16 a[186:187], v26 offset:9216
    ds_read_b64_tr_b16 a[188:189], v27 offset:8192
    ds_read_b64_tr_b16 a[190:191], v27 offset:9216
    ds_read_b64_tr_b16 a[192:193], v24 offset:12288
    ds_read_b64_tr_b16 a[194:195], v24 offset:13312
    ds_read_b64_tr_b16 a[196:197], v25 offset:12288
    ds_read_b64_tr_b16 a[198:199], v25 offset:13312
    ds_read_b64_tr_b16 a[200:201], v26 offset:12288
    ds_read_b64_tr_b16 a[202:203], v26 offset:13312
    ds_read_b64_tr_b16 a[204:205], v27 offset:12288
    ds_read_b64_tr_b16 a[206:207], v27 offset:13312
    v_mov_b32 v118, 0
    s_mov_b64 exec, 3
    buffer_atomic_add v118, v116, s[28:31], s36 offen sc0 sc1
    s_mov_b64 exec, -1
    s_waitcnt lgkmcnt(15)
    s_mul_i32 s54, s6, s101
    s_add_u32 m0, s55, 4096
    s_nop 0
    buffer_load_dwordx4 v16, s[16:19], s54 offen offset:0 sc1 lds
    buffer_load_dwordx4 v17, s[16:19], s54 offen offset:1024 sc1 lds
    buffer_load_dwordx4 v18, s[16:19], s54 offen offset:2048 sc1 lds
    buffer_load_dwordx4 v19, s[16:19], s54 offen offset:3072 sc1 lds
    ds_read_b64_tr_b16 a[208:209], v24 offset:16384
    ds_read_b64_tr_b16 a[210:211], v24 offset:17408
    ds_read_b64_tr_b16 a[212:213], v25 offset:16384
    ds_read_b64_tr_b16 a[214:215], v25 offset:17408
    ds_read_b64_tr_b16 a[216:217], v26 offset:16384
    ds_read_b64_tr_b16 a[218:219], v26 offset:17408
    ds_read_b64_tr_b16 a[220:221], v27 offset:16384
    ds_read_b64_tr_b16 a[222:223], v27 offset:17408
    s_waitcnt vmcnt(17)
    ds_read_b64_tr_b16 a[224:225], v20 offset:0
    ds_read_b64_tr_b16 a[226:227], v20 offset:1024
    ds_read_b64_tr_b16 a[228:229], v21 offset:0
    ds_read_b64_tr_b16 a[230:231], v21 offset:1024
    ds_read_b64_tr_b16 a[232:233], v22 offset:0
    ds_read_b64_tr_b16 a[234:235], v22 offset:1024
    ds_read_b64_tr_b16 a[236:237], v23 offset:0
    ds_read_b64_tr_b16 a[238:239], v23 offset:1024
    s_cmp_ge_u32 s45, 30
    s_cbranch_scc1 L_p4_28
    s_waitcnt vmcnt(4)
    v_cmp_gt_u32 vcc, 8, v118
    s_mov_b32 s57, 0
    s_and_b32 vcc_lo, vcc_lo, 3
    s_cbranch_scc1 L_slow_D_30
L_back_D_31:
    v_add_u32 v114, s82, v4
    buffer_load_dwordx4 v[176:179], v114, s[28:31], s64 offen sc1
    buffer_load_dwordx4 v[180:183], v114, s[28:31], s65 offen sc1
    buffer_load_dwordx4 v[184:187], v114, s[28:31], s66 offen sc1
    buffer_load_dwordx4 v[188:191], v114, s[28:31], s67 offen sc1
    buffer_load_dwordx4 v[192:195], v114, s[28:31], s68 offen sc1
    buffer_load_dwordx4 v[196:199], v114, s[28:31], s69 offen sc1
    buffer_load_dwordx4 v[200:203], v114, s[28:31], s70 offen sc1
    buffer_load_dwordx4 v[204:207], v114, s[28:31], s71 offen sc1
    ds_read_b64_tr_b16 a[240:241], v20 offset:4096
    ds_read_b64_tr_b16 a[242:243], v20 offset:5120
    ds_read_b64_tr_b16 a[244:245], v21 offset:4096
    ds_read_b64_tr_b16 a[246:247], v21 offset:5120
    ds_read_b64_tr_b16 a[248:249], v22 offset:4096
    ds_read_b64_tr_b16 a[250:251], v22 offset:5120
    ds_read_b64_tr_b16 a[252:253], v23 offset:4096
    ds_read_b64_tr_b16 a[254:255], v23 offset:5120
    buffer_load_dwordx4 v[208:211], v114, s[28:31], s72 offen sc1
    buffer_load_dwordx4 v[212:215], v114, s[28:31], s73 offen sc1
    buffer_load_dwordx4 v[216:219], v114, s[28:31], s74 offen sc1
    buffer_load_dwordx4 v[220:223], v114, s[28:31], s75 offen sc1
    s_waitcnt lgkmcnt(0)
    s_waitcnt vmcnt(11)
    v_mfma_f32_16x16x32_bf16 v[36:39], a[0:3], v[176:179], v[120:123]
    buffer_load_dwordx4 v[224:227], v114, s[28:31], s76 offen sc1
    v_mfma_f32_16x16x32_bf16 v[40:43], a[4:7], v[176:179], 0
    v_mfma_f32_16x16x32_bf16 v[44:47], a[8:11], v[176:179], 0
    v_mfma_f32_16x16x32_bf16 v[48:51], a[12:15], v[176:179], 0
    s_waitcnt vmcnt(11)
    v_mfma_f32_16x16x32_bf16 v[36:39], a[16:19], v[180:183], v[36:39]
    buffer_load_dwordx4 v[228:231], v114, s[28:31], s77 offen sc1
    v_mfma_f32_16x16x32_bf16 v[40:43], a[20:23], v[180:183], v[40:43]
    v_mfma_f32_16x16x32_bf16 v[44:47], a[24:27], v[180:183], v[44:47]
    v_mfma_f32_16x16x32_bf16 v[48:51], a[28:31], v[180:183], v[48:51]
    s_waitcnt vmcnt(11)
    v_mfma_f32_16x16x32_bf16 v[36:39], a[32:35], v[184:187], v[36:39]
    buffer_load_dwordx4 v[232:235], v114, s[28:31], s78 offen sc1
    v_mfma_f32_16x16x32_bf16 v[40:43], a[36:39], v[184:187], v[40:43]
    v_mfma_f32_16x16x32_bf16 v[44:47], a[40:43], v[184:187], v[44:47]
    v_mfma_f32_16x16x32_bf16 v[48:51], a[44:47], v[184:187], v[48:51]
    s_waitcnt vmcnt(11)
    v_mfma_f32_16x16x32_bf16 v[36:39], a[48:51], v[188:191], v[36:39]
    buffer_load_dwordx4 v[236:239], v114, s[28:31], s79 offen sc1
    v_mfma_f32_16x16x32_bf16 v[40:43], a[52:55], v[188:191], v[40:43]
    v_mfma_f32_16x16x32_bf16 v[44:47], a[56:59], v[188:191], v[44:47]
    v_mfma_f32_16x16x32_bf16 v[48:51], a[60:63], v[188:191], v[48:51]
    s_waitcnt vmcnt(11)
    v_mfma_f32_16x16x32_bf16 v[36:39], a[64:67], v[192:195], v[36:39]
    v_add_u32 v114, s83, v4
    buffer_load_dwordx4 v[240:243], v114, s[28:31], s64 offen sc1
    v_mfma_f32_16x16x32_bf16 v[40:43], a[68:71], v[192:195], v[40:43]
    v_mfma_f32_16x16x32_bf16 v[44:47], a[72:75], v[192:195], v[44:47]
    v_mfma_f32_16x16x32_bf16 v[48:51], a[76:79], v[192:195], v[48:51]
    s_waitcnt vmcnt(11)
    v_mfma_f32_16x16x32_bf16 v[36:39], a[80:83], v[196:199], v[36:39]
    buffer_load_dwordx4 v[244:247], v114, s[28:31], s65 offen sc1
    v_mfma_f32_16x16x32_bf16 v[40:43], a[84:87], v[196:199], v[40:43]
    v_mfma_f32_16x16x32_bf16 v[44:47], a[88:91], v[196:199], v[44:47]
    v_mfma_f32_16x16x32_bf16 v[48:51], a[92:95], v[196:199], v[48:51]
    s_waitcnt vmcnt(11)
    v_mfma_f32_16x16x32_bf16 v[36:39], a[96:99], v[200:203], v[36:39]
    buffer_load_dwordx4 v[248:251], v114, s[28:31], s66 offen sc1
    v_mfma_f32_16x16x32_bf16 v[40:43], a[100:103], v[200:203], v[40:43]
    v_mfma_f32_16x16x32_bf16 v[44:47], a[104:107], v[200:203], v[44:47]
    v_mfma_f32_16x16x32_bf16 v[48:51], a[108:111], v[200:203], v[48:51]
    s_waitcnt vmcnt(11)
    v_mfma_f32_16x16x32_bf16 v[36:39], a[112:115], v[204:207], v[36:39]
    buffer_load_dwordx4 v[252:255], v114, s[28:31], s67 offen sc1
    v_mfma_f32_16x16x32_bf16 v[40:43], a[116:119], v[204:207], v[40:43]
    v_mfma_f32_16x16x32_bf16 v[44:47], a[120:123], v[204:207], v[44:47]
    v_mfma_f32_16x16x32_bf16 v[48:51], a[124:127], v[204:207], v[48:51]
    s_waitcnt vmcnt(11)
    v_mfma_f32_16x16x32_bf16 v[36:39], a[128:131], v[208:211], v[36:39]
    buffer_load_dwordx4 v[176:179], v114, s[28:31], s68 offen sc1
    v_mfma_f32_16x16x32_bf16 v[40:43], a[132:135], v[208:211], v[40:43]
    v_mfma_f32_16x16x32_bf16 v[44:47], a[136:139], v[208:211], v[44:47]
    v_mfma_f32_16x16x32_bf16 v[48:51], a[140:143], v[208:211], v[48:51]
    s_waitcnt vmcnt(11)
    v_mfma_f32_16x16x32_bf16 v[36:39], a[144:147], v[212:215], v[36:39]
    buffer_load_dwordx4 v[180:183], v114, s[28:31], s69 offen sc1
    v_mfma_f32_16x16x32_bf16 v[40:43], a[148:151], v[212:215], v[40:43]
    v_mfma_f32_16x16x32_bf16 v[44:47], a[152:155], v[212:215], v[44:47]
    v_mfma_f32_16x16x32_bf16 v[48:51], a[156:159], v[212:215], v[48:51]
    s_waitcnt vmcnt(11)
    v_mfma_f32_16x16x32_bf16 v[36:39], a[160:163], v[216:219], v[36:39]
    buffer_load_dwordx4 v[184:187], v114, s[28:31], s70 offen sc1
    v_mfma_f32_16x16x32_bf16 v[40:43], a[164:167], v[216:219], v[40:43]
    v_mfma_f32_16x16x32_bf16 v[44:47], a[168:171], v[216:219], v[44:47]
    v_mfma_f32_16x16x32_bf16 v[48:51], a[172:175], v[216:219], v[48:51]
    s_waitcnt vmcnt(11)
    v_mfma_f32_16x16x32_bf16 v[36:39], a[176:179], v[220:223], v[36:39]
    buffer_load_dwordx4 v[188:191], v114, s[28:31], s71 offen sc1
    v_mfma_f32_16x16x32_bf16 v[40:43], a[180:183], v[220:223], v[40:43]
    v_mfma_f32_16x16x32_bf16 v[44:47], a[184:187], v[220:223], v[44:47]
    v_mfma_f32_16x16x32_bf16 v[48:51], a[188:191], v[220:223], v[48:51]
    s_waitcnt vmcnt(11)
    v_mfma_f32_16x16x32_bf16 v[36:39], a[192:195], v[224:227], v[36:39]
    buffer_load_dwordx4 v[192:195], v114, s[28:31], s72 offen sc1
    v_mfma_f32_16x16x32_bf16 v[40:43], a[196:199], v[224:227], v[40:43]
    v_mfma_f32_16x16x32_bf16 v[44:47], a[200:203], v[224:227], v[44:47]
    v_mfma_f32_16x16x32_bf16 v[48:51], a[204:207], v[224:227], v[48:51]
    s_waitcnt vmcnt(11)
    v_mfma_f32_16x16x32_bf16 v[36:39], a[208:211], v[228:231], v[36:39]
    buffer_load_dwordx4 v[196:199], v114, s[28:31], s73 offen sc1
    v_mfma_f32_16x16x32_bf16 v[40:43], a[212:215], v[228:231], v[40:43]
    v_mfma_f32_16x16x32_bf16 v[44:47], a[216:219], v[228:231], v[44:47]
    v_mfma_f32_16x16x32_bf16 v[48:51], a[220:223], v[228:231], v[48:51]
    s_waitcnt vmcnt(11)
    v_mfma_f32_16x16x32_bf16 v[36:39], a[224:227], v[232:235], v[36:39]
    buffer_load_dwordx4 v[200:203], v114, s[28:31], s74 offen sc1
    v_mfma_f32_16x16x32_bf16 v[40:43], a[228:231], v[232:235], v[40:43]
    v_mfma_f32_16x16x32_bf16 v[44:47], a[232:235], v[232:235], v[44:47]
    v_mfma_f32_16x16x32_bf16 v[48:51], a[236:239], v[232:235], v[48:51]
    s_waitcnt vmcnt(11)
    v_mfma_f32_16x16x32_bf16 v[36:39], a[240:243], v[236:239], v[36:39]
    buffer_load_dwordx4 v[204:207], v114, s[28:31], s75 offen sc1
    v_mfma_f32_16x16x32_bf16 v[40:43], a[244:247], v[236:239], v[40:43]
    v_mfma_f32_16x16x32_bf16 v[44:47], a[248:251], v[236:239], v[44:47]
    v_mfma_f32_16x16x32_bf16 v[48:51], a[252:255], v[236:239], v[48:51]
    s_waitcnt vmcnt(11)
    v_mfma_f32_16x16x32_bf16 v[52:55], a[0:3], v[240:243], v[120:123]
    buffer_load_dwordx4 v[208:211], v114, s[28:31], s76 offen sc1
    v_mfma_f32_16x16x32_bf16 v[56:59], a[4:7], v[240:243], 0
    v_mfma_f32_16x16x32_bf16 v[60:63], a[8:11], v[240:243], 0
    v_mfma_f32_16x16x32_bf16 v[64:67], a[12:15], v[240:243], 0
    s_waitcnt vmcnt(11)
    v_mfma_f32_16x16x32_bf16 v[52:55], a[16:19], v[244:247], v[52:55]
    buffer_load_dwordx4 v[212:215], v114, s[28:31], s77 offen sc1
    v_mfma_f32_16x16x32_bf16 v[56:59], a[20:23], v[244:247], v[56:59]
    ds_write_b128 v110, v[40:43] offset:12288
    v_mfma_f32_16x16x32_bf16 v[60:63], a[24:27], v[244:247], v[60:63]
    v_mfma_f32_16x16x32_bf16 v[64:67], a[28:31], v[244:247], v[64:67]
    s_waitcnt vmcnt(11)
    v_mfma_f32_16x16x32_bf16 v[52:55], a[32:35], v[248:251], v[52:55]
    buffer_load_dwordx4 v[216:219], v114, s[28:31], s78 offen sc1
    v_mfma_f32_16x16x32_bf16 v[56:59], a[36:39], v[248:251], v[56:59]
    ds_write_b128 v111, v[44:47] offset:12288
    v_mfma_f32_16x16x32_bf16 v[60:63], a[40:43], v[248:251], v[60:63]
    v_mfma_f32_16x16x32_bf16 v[64:67], a[44:47], v[248:251], v[64:67]
    s_waitcnt vmcnt(11)
    v_mfma_f32_16x16x32_bf16 v[52:55], a[48:51], v[252:255], v[52:55]
    buffer_load_dwordx4 v[220:223], v114, s[28:31], s79 offen sc1
    v_mfma_f32_16x16x32_bf16 v[56:59], a[52:55], v[252:255], v[56:59]
    ds_write_b128 v112, v[48:51] offset:12288
    v_mfma_f32_16x16x32_bf16 v[60:63], a[56:59], v[252:255], v[60:63]
    v_mfma_f32_16x16x32_bf16 v[64:67], a[60:63], v[252:255], v[64:67]
    s_waitcnt vmcnt(11)
    v_mfma_f32_16x16x32_bf16 v[52:55], a[64:67], v[176:179], v[52:55]
    v_add_u32 v114, s84, v4
    buffer_load_dwordx4 v[224:227], v114, s[28:31], s64 offen sc1
    v_mfma_f32_16x16x32_bf16 v[56:59], a[68:71], v[176:179], v[56:59]
    s_waitcnt lgkmcnt(0)
    s_barrier
    v_mfma_f32_16x16x32_bf16 v[60:63], a[72:75], v[176:179], v[60:63]
    ds_read_b128 v[68:71], v113 offset:12288
    v_mfma_f32_16x16x32_bf16 v[64:67], a[76:79], v[176:179], v[64:67]
    ds_read_b128 v[72:75], v113 offset:13312
    s_waitcnt vmcnt(11)
    v_mfma_f32_16x16x32_bf16 v[52:55], a[80:83], v[180:183], v[52:55]
    buffer_load_dwordx4 v[228:231], v114, s[28:31], s65 offen sc1
    v_mfma_f32_16x16x32_bf16 v[56:59], a[84:87], v[180:183], v[56:59]
    ds_read_b128 v[76:79], v113 offset:14336
    v_mfma_f32_16x16x32_bf16 v[60:63], a[88:91], v[180:183], v[60:63]
    v_mfma_f32_16x16x32_bf16 v[64:67], a[92:95], v[180:183], v[64:67]
    s_waitcnt vmcnt(11)
    v_mfma_f32_16x16x32_bf16 v[52:55], a[96:99], v[184:187], v[52:55]
    buffer_load_dwordx4 v[232:235], v114, s[28:31], s66 offen sc1
    v_mfma_f32_16x16x32_bf16 v[56:59], a[100:103], v[184:187], v[56:59]
    s_waitcnt lgkmcnt(2)
    v_add_f32 v36, v36, v68
    v_add_f32 v37, v37, v69
    v_add_f32 v38, v38, v70
    v_add_f32 v39, v39, v71
    v_mfma_f32_16x16x32_bf16 v[60:63], a[104:107], v[184:187], v[60:63]
    s_waitcnt lgkmcnt(1)
    v_add_f32 v36, v36, v72
    v_add_f32 v37, v37, v73
    v_add_f32 v38, v38, v74
    v_add_f32 v39, v39, v75
    v_mfma_f32_16x16x32_bf16 v[64:67], a[108:111], v[184:187], v[64:67]
    s_waitcnt lgkmcnt(0)
    v_add_f32 v36, v36, v76
    s_waitcnt vmcnt(11)
    v_mfma_f32_16x16x32_bf16 v[52:55], a[112:115], v[188:191], v[52:55]
    buffer_load_dwordx4 v[236:239], v114, s[28:31], s67 offen sc1
    v_mfma_f32_16x16x32_bf16 v[56:59], a[116:119], v[188:191], v[56:59]
    v_add_f32 v37, v37, v77
    v_add_f32 v38, v38, v78
    v_mfma_f32_16x16x32_bf16 v[60:63], a[120:123], v[188:191], v[60:63]
    v_add_f32 v39, v39, v79
    v_mul_f32 v68, v36, v36
    v_mfma_f32_16x16x32_bf16 v[64:67], a[124:127], v[188:191], v[64:67]
    v_mul_f32 v69, v37, v37
    s_waitcnt vmcnt(11)
    v_mfma_f32_16x16x32_bf16 v[52:55], a[128:131], v[192:195], v[52:55]
    buffer_load_dwordx4 v[240:243], v114, s[28:31], s68 offen sc1
    v_mfma_f32_16x16x32_bf16 v[56:59], a[132:135], v[192:195], v[56:59]
    v_mul_f32 v70, v38, v38
    v_mul_f32 v71, v39, v39
    v_mfma_f32_16x16x32_bf16 v[60:63], a[136:139], v[192:195], v[60:63]
    v_fma_f32 v68, v68, s58, v130
    v_fma_f32 v69, v69, s58, v130
    v_mfma_f32_16x16x32_bf16 v[64:67], a[140:143], v[192:195], v[64:67]
    v_fma_f32 v70, v70, s58, v130
    s_waitcnt vmcnt(11)
    v_mfma_f32_16x16x32_bf16 v[52:55], a[144:147], v[196:199], v[52:55]
    buffer_load_dwordx4 v[244:247], v114, s[28:31], s69 offen sc1
    v_mfma_f32_16x16x32_bf16 v[56:59], a[148:151], v[196:199], v[56:59]
    v_fma_f32 v71, v71, s58, v130
    v_mul_f32 v68, v68, v36
    v_mfma_f32_16x16x32_bf16 v[60:63], a[152:155], v[196:199], v[60:63]
    v_mul_f32 v69, v69, v37
    v_mul_f32 v70, v70, v38
    v_mfma_f32_16x16x32_bf16 v[64:67], a[156:159], v[196:199], v[64:67]
    v_mul_f32 v71, v71, v39
    s_waitcnt vmcnt(11)
    v_mfma_f32_16x16x32_bf16 v[52:55], a[160:163], v[200:203], v[52:55]
    buffer_load_dwordx4 v[248:251], v114, s[28:31], s70 offen sc1
    v_mfma_f32_16x16x32_bf16 v[56:59], a[164:167], v[200:203], v[56:59]
    v_exp_f32 v68, v68
    v_mfma_f32_16x16x32_bf16 v[60:63], a[168:171], v[200:203], v[60:63]
    v_exp_f32 v69, v69
    v_mfma_f32_16x16x32_bf16 v[64:67], a[172:175], v[200:203], v[64:67]
    v_exp_f32 v70, v70
    s_waitcnt vmcnt(11)
    v_mfma_f32_16x16x32_bf16 v[52:55], a[176:179], v[204:207], v[52:55]
    buffer_load_dwordx4 v[252:255], v114, s[28:31], s71 offen sc1
    v_mfma_f32_16x16x32_bf16 v[56:59], a[180:183], v[204:207], v[56:59]
    v_exp_f32 v71, v71
    v_add_f32 v68, 1.0, v68
    v_mfma_f32_16x16x32_bf16 v[60:63], a[184:187], v[204:207], v[60:63]
    v_add_f32 v69, 1.0, v69
    v_add_f32 v70, 1.0, v70
    v_mfma_f32_16x16x32_bf16 v[64:67], a[188:191], v[204:207], v[64:67]
    v_add_f32 v71, 1.0, v71
    s_waitcnt vmcnt(11)
    v_mfma_f32_16x16x32_bf16 v[52:55], a[192:195], v[208:211], v[52:55]
    buffer_load_dwordx4 v[176:179], v114, s[28:31], s72 offen sc1
    v_mfma_f32_16x16x32_bf16 v[56:59], a[196:199], v[208:211], v[56:59]
    v_rcp_f32 v68, v68
    v_mfma_f32_16x16x32_bf16 v[60:63], a[200:203], v[208:211], v[60:63]
    v_rcp_f32 v69, v69
    v_mfma_f32_16x16x32_bf16 v[64:67], a[204:207], v[208:211], v[64:67]
    v_rcp_f32 v70, v70
    s_waitcnt vmcnt(11)
    v_mfma_f32_16x16x32_bf16 v[52:55], a[208:211], v[212:215], v[52:55]
    buffer_load_dwordx4 v[180:183], v114, s[28:31], s73 offen sc1
    v_mfma_f32_16x16x32_bf16 v[56:59], a[212:215], v[212:215], v[56:59]
    v_rcp_f32 v71, v71
    v_mul_f32 v68, v68, v36
    v_mfma_f32_16x16x32_bf16 v[60:63], a[216:219], v[212:215], v[60:63]
    v_mul_f32 v69, v69, v37
    v_mul_f32 v70, v70, v38
    v_mfma_f32_16x16x32_bf16 v[64:67], a[220:223], v[212:215], v[64:67]
    v_mul_f32 v71, v71, v39
    s_waitcnt vmcnt(11)
    v_mfma_f32_16x16x32_bf16 v[52:55], a[224:227], v[216:219], v[52:55]
    buffer_load_dwordx4 v[184:187], v114, s[28:31], s74 offen sc1
    v_mfma_f32_16x16x32_bf16 v[56:59], a[228:231], v[216:219], v[56:59]
    v_cvt_pk_bf16_f32 v132, v68, v69
    v_cvt_pk_bf16_f32 v133, v70, v71
    v_mfma_f32_16x16x32_bf16 v[60:63], a[232:235], v[216:219], v[60:63]
    v_cvt_pk_bf16_f32 v134, v68, v69
    v_cvt_pk_bf16_f32 v135, v70, v71
    v_mfma_f32_16x16x32_bf16 v[64:67], a[236:239], v[216:219], v[64:67]
    v_permlane32_swap_b32 v132, v134
    s_waitcnt vmcnt(11)
    v_mfma_f32_16x16x32_bf16 v[52:55], a[240:243], v[220:223], v[52:55]
    buffer_load_dwordx4 v[188:191], v114, s[28:31], s75 offen sc1
    v_mfma_f32_16x16x32_bf16 v[56:59], a[244:247], v[220:223], v[56:59]
    v_permlane32_swap_b32 v133, v135
    v_mfma_f32_16x16x32_bf16 v[60:63], a[248:251], v[220:223], v[60:63]
    s_mov_b32 exec_hi, 0
    buffer_store_dwordx4 v[132:135], v4, s[28:31], s86 offen sc1
    s_mov_b32 exec_hi, -1
    v_mfma_f32_16x16x32_bf16 v[64:67], a[252:255], v[220:223], v[64:67]
    s_waitcnt vmcnt(12)
    v_mfma_f32_16x16x32_bf16 v[36:39], a[0:3], v[224:227], v[120:123]
    buffer_load_dwordx4 v[192:195], v114, s[28:31], s76 offen sc1
    v_mfma_f32_16x16x32_bf16 v[40:43], a[4:7], v[224:227], 0
    v_mfma_f32_16x16x32_bf16 v[44:47], a[8:11], v[224:227], 0
    v_mfma_f32_16x16x32_bf16 v[48:51], a[12:15], v[224:227], 0
    s_waitcnt vmcnt(12)
    v_mfma_f32_16x16x32_bf16 v[36:39], a[16:19], v[228:231], v[36:39]
    buffer_load_dwordx4 v[196:199], v114, s[28:31], s77 offen sc1
    v_mfma_f32_16x16x32_bf16 v[40:43], a[20:23], v[228:231], v[40:43]
    ds_write_b128 v110, v[56:59] offset:0
    v_mfma_f32_16x16x32_bf16 v[44:47], a[24:27], v[228:231], v[44:47]
    v_mfma_f32_16x16x32_bf16 v[48:51], a[28:31], v[228:231], v[48:51]
    s_waitcnt vmcnt(12)
    v_mfma_f32_16x16x32_bf16 v[36:39], a[32:35], v[232:235], v[36:39]
    buffer_load_dwordx4 v[200:203], v114, s[28:31], s78 offen sc1
    v_mfma_f32_16x16x32_bf16 v[40:43], a[36:39], v[232:235], v[40:43]
    ds_write_b128 v111, v[60:63] offset:0
    v_mfma_f32_16x16x32_bf16 v[44:47], a[40:43], v[232:235], v[44:47]
    v_mfma_f32_16x16x32_bf16 v[48:51], a[44:47], v[232:235], v[48:51]
    s_waitcnt vmcnt(12)
    v_mfma_f32_16x16x32_bf16 v[36:39], a[48:51], v[236:239], v[36:39]
    buffer_load_dwordx4 v[204:207], v114, s[28:31], s79 offen sc1
    v_mfma_f32_16x16x32_bf16 v[40:43], a[52:55], v[236:239], v[40:43]
    ds_write_b128 v112, v[64:67] offset:0
    v_mfma_f32_16x16x32_bf16 v[44:47], a[56:59], v[236:239], v[44:47]
    v_mfma_f32_16x16x32_bf16 v[48:51], a[60:63], v[236:239], v[48:51]
    s_waitcnt vmcnt(12)
    v_mfma_f32_16x16x32_bf16 v[36:39], a[64:67], v[240:243], v[36:39]
    v_add_u32 v114, s85, v4
    buffer_load_dwordx4 v[208:211], v114, s[28:31], s64 offen sc1
    v_mfma_f32_16x16x32_bf16 v[40:43], a[68:71], v[240:243], v[40:43]
    s_waitcnt lgkmcnt(0)
    s_barrier
    v_mfma_f32_16x16x32_bf16 v[44:47], a[72:75], v[240:243], v[44:47]
    ds_read_b128 v[68:71], v113 offset:0
    v_mfma_f32_16x16x32_bf16 v[48:51], a[76:79], v[240:243], v[48:51]
    ds_read_b128 v[72:75], v113 offset:1024
    s_waitcnt vmcnt(12)
    v_mfma_f32_16x16x32_bf16 v[36:39], a[80:83], v[244:247], v[36:39]
    buffer_load_dwordx4 v[212:215], v114, s[28:31], s65 offen sc1
    v_mfma_f32_16x16x32_bf16 v[40:43], a[84:87], v[244:247], v[40:43]
    ds_read_b128 v[76:79], v113 offset:2048
    v_mfma_f32_16x16x32_bf16 v[44:47], a[88:91], v[244:247], v[44:47]
    v_mfma_f32_16x16x32_bf16 v[48:51], a[92:95], v[244:247], v[48:51]
    s_waitcnt vmcnt(12)
    v_mfma_f32_16x16x32_bf16 v[36:39], a[96:99], v[248:251], v[36:39]
    buffer_load_dwordx4 v[216:219], v114, s[28:31], s66 offen sc1
    v_mfma_f32_16x16x32_bf16 v[40:43], a[100:103], v[248:251], v[40:43]
    s_waitcnt lgkmcnt(2)
    v_add_f32 v52, v52, v68
    v_add_f32 v53, v53, v69
    v_add_f32 v54, v54, v70
    v_add_f32 v55, v55, v71
    v_mfma_f32_16x16x32_bf16 v[44:47], a[104:107], v[248:251], v[44:47]
    s_waitcnt lgkmcnt(1)
    v_add_f32 v52, v52, v72
    v_add_f32 v53, v53, v73
    v_add_f32 v54, v54, v74
    v_add_f32 v55, v55, v75
    v_mfma_f32_16x16x32_bf16 v[48:51], a[108:111], v[248:251], v[48:51]
    s_waitcnt lgkmcnt(0)
    v_add_f32 v52, v52, v76
    v_add_f32 v53, v53, v77
    v_add_f32 v54, v54, v78
    v_add_f32 v55, v55, v79
    s_waitcnt vmcnt(12)
    v_mfma_f32_16x16x32_bf16 v[36:39], a[112:115], v[252:255], v[36:39]
    buffer_load_dwordx4 v[220:223], v114, s[28:31], s67 offen sc1
    v_mfma_f32_16x16x32_bf16 v[40:43], a[116:119], v[252:255], v[40:43]
    v_mul_f32 v68, v52, v52
    v_mul_f32 v69, v53, v53
    v_mfma_f32_16x16x32_bf16 v[44:47], a[120:123], v[252:255], v[44:47]
    v_mul_f32 v70, v54, v54
    v_mul_f32 v71, v55, v55
    v_mfma_f32_16x16x32_bf16 v[48:51], a[124:127], v[252:255], v[48:51]
    v_fma_f32 v68, v68, s58, v130
    s_waitcnt vmcnt(12)
    v_mfma_f32_16x16x32_bf16 v[36:39], a[128:131], v[176:179], v[36:39]
    buffer_load_dwordx4 v[224:227], v114, s[28:31], s68 offen sc1
    v_mfma_f32_16x16x32_bf16 v[40:43], a[132:135], v[176:179], v[40:43]
    v_fma_f32 v69, v69, s58, v130
    v_fma_f32 v70, v70, s58, v130
    v_mfma_f32_16x16x32_bf16 v[44:47], a[136:139], v[176:179], v[44:47]
    v_fma_f32 v71, v71, s58, v130
    v_mul_f32 v68, v68, v52
    v_mfma_f32_16x16x32_bf16 v[48:51], a[140:143], v[176:179], v[48:51]
    v_mul_f32 v69, v69, v53
    s_waitcnt vmcnt(12)
    v_mfma_f32_16x16x32_bf16 v[36:39], a[144:147], v[180:183], v[36:39]
    buffer_load_dwordx4 v[228:231], v114, s[28:31], s69 offen sc1
    v_mfma_f32_16x16x32_bf16 v[40:43], a[148:151], v[180:183], v[40:43]
    v_mul_f32 v70, v70, v54
    v_mul_f32 v71, v71, v55
    v_mfma_f32_16x16x32_bf16 v[44:47], a[152:155], v[180:183], v[44:47]
    v_exp_f32 v68, v68
    v_mfma_f32_16x16x32_bf16 v[48:51], a[156:159], v[180:183], v[48:51]
    v_exp_f32 v69, v69
    s_waitcnt vmcnt(12)
    v_mfma_f32_16x16x32_bf16 v[36:39], a[160:163], v[184:187], v[36:39]
    buffer_load_dwordx4 v[232:235], v114, s[28:31], s70 offen sc1
    v_mfma_f32_16x16x32_bf16 v[40:43], a[164:167], v[184:187], v[40:43]
    v_exp_f32 v70, v70
    v_mfma_f32_16x16x32_bf16 v[44:47], a[168:171], v[184:187], v[44:47]
    v_exp_f32 v71, v71
    v_add_f32 v68, 1.0, v68
    v_mfma_f32_16x16x32_bf16 v[48:51], a[172:175], v[184:187], v[48:51]
    v_add_f32 v69, 1.0, v69
    s_waitcnt vmcnt(12)
    v_mfma_f32_16x16x32_bf16 v[36:39], a[176:179], v[188:191], v[36:39]
    buffer_load_dwordx4 v[236:239], v114, s[28:31], s71 offen sc1
    v_mfma_f32_16x16x32_bf16 v[40:43], a[180:183], v[188:191], v[40:43]
    v_add_f32 v70, 1.0, v70
    v_add_f32 v71, 1.0, v71
    v_mfma_f32_16x16x32_bf16 v[44:47], a[184:187], v[188:191], v[44:47]
    v_rcp_f32 v68, v68
    v_mfma_f32_16x16x32_bf16 v[48:51], a[188:191], v[188:191], v[48:51]
    v_rcp_f32 v69, v69
    s_waitcnt vmcnt(11)
    v_mfma_f32_16x16x32_bf16 v[36:39], a[192:195], v[192:195], v[36:39]
    buffer_load_dwordx4 v[240:243], v114, s[28:31], s72 offen sc1
    v_mfma_f32_16x16x32_bf16 v[40:43], a[196:199], v[192:195], v[40:43]
    v_rcp_f32 v70, v70
    v_mfma_f32_16x16x32_bf16 v[44:47], a[200:203], v[192:195], v[44:47]
    v_rcp_f32 v71, v71
    v_mfma_f32_16x16x32_bf16 v[48:51], a[204:207], v[192:195], v[48:51]
    v_mul_f32 v68, v68, v52
    s_waitcnt vmcnt(11)
    v_mfma_f32_16x16x32_bf16 v[36:39], a[208:211], v[196:199], v[36:39]
    buffer_load_dwordx4 v[244:247], v114, s[28:31], s73 offen sc1
    v_mfma_f32_16x16x32_bf16 v[40:43], a[212:215], v[196:199], v[40:43]
    s_mov_b64 exec, 15
    buffer_atomic_add v5, v137, s[28:31], s88 offen sc1
    s_mov_b64 exec, -1
    v_mfma_f32_16x16x32_bf16 v[44:47], a[216:219], v[196:199], v[44:47]
    v_mul_f32 v69, v69, v53
    v_mul_f32 v70, v70, v54
    v_mfma_f32_16x16x32_bf16 v[48:51], a[220:223], v[196:199], v[48:51]
    v_mul_f32 v71, v71, v55
    s_waitcnt vmcnt(12)
    v_mfma_f32_16x16x32_bf16 v[36:39], a[224:227], v[200:203], v[36:39]
    buffer_load_dwordx4 v[248:251], v114, s[28:31], s74 offen sc1
    v_mfma_f32_16x16x32_bf16 v[40:43], a[228:231], v[200:203], v[40:43]
    v_cvt_pk_bf16_f32 v132, v68, v69
    v_cvt_pk_bf16_f32 v133, v70, v71
    v_mfma_f32_16x16x32_bf16 v[44:47], a[232:235], v[200:203], v[44:47]
    v_cvt_pk_bf16_f32 v134, v68, v69
    v_cvt_pk_bf16_f32 v135, v70, v71
    v_mfma_f32_16x16x32_bf16 v[48:51], a[236:239], v[200:203], v[48:51]
    v_permlane32_swap_b32 v132, v134
    s_waitcnt vmcnt(12)
    v_mfma_f32_16x16x32_bf16 v[36:39], a[240:243], v[204:207], v[36:39]
    buffer_load_dwordx4 v[252:255], v114, s[28:31], s75 offen sc1
    v_mfma_f32_16x16x32_bf16 v[40:43], a[244:247], v[204:207], v[40:43]
    v_permlane32_swap_b32 v133, v135
    v_mfma_f32_16x16x32_bf16 v[44:47], a[248:251], v[204:207], v[44:47]
    s_mov_b32 exec_hi, 0
    buffer_store_dwordx4 v[132:135], v4, s[28:31], s87 offen sc1
    s_mov_b32 exec_hi, -1
    v_mfma_f32_16x16x32_bf16 v[48:51], a[252:255], v[204:207], v[48:51]
    s_waitcnt vmcnt(13)
    v_mfma_f32_16x16x32_bf16 v[52:55], a[0:3], v[208:211], v[120:123]
    buffer_load_dwordx4 v[176:179], v114, s[28:31], s76 offen sc1
    v_mfma_f32_16x16x32_bf16 v[56:59], a[4:7], v[208:211], 0
    v_mfma_f32_16x16x32_bf16 v[60:63], a[8:11], v[208:211], 0
    v_mfma_f32_16x16x32_bf16 v[64:67], a[12:15], v[208:211], 0
    s_waitcnt vmcnt(13)
    v_mfma_f32_16x16x32_bf16 v[52:55], a[16:19], v[212:215], v[52:55]
    buffer_load_dwordx4 v[180:183], v114, s[28:31], s77 offen sc1
    v_mfma_f32_16x16x32_bf16 v[56:59], a[20:23], v[212:215], v[56:59]
    ds_write_b128 v110, v[40:43] offset:12288
    v_mfma_f32_16x16x32_bf16 v[60:63], a[24:27], v[212:215], v[60:63]
    v_mfma_f32_16x16x32_bf16 v[64:67], a[28:31], v[212:215], v[64:67]
    s_waitcnt vmcnt(13)
    v_mfma_f32_16x16x32_bf16 v[52:55], a[32:35], v[216:219], v[52:55]
    buffer_load_dwordx4 v[184:187], v114, s[28:31], s78 offen sc1
    v_mfma_f32_16x16x32_bf16 v[56:59], a[36:39], v[216:219], v[56:59]
    ds_write_b128 v111, v[44:47] offset:12288
    v_mfma_f32_16x16x32_bf16 v[60:63], a[40:43], v[216:219], v[60:63]
    v_mfma_f32_16x16x32_bf16 v[64:67], a[44:47], v[216:219], v[64:67]
    s_waitcnt vmcnt(13)
    v_mfma_f32_16x16x32_bf16 v[52:55], a[48:51], v[220:223], v[52:55]
    buffer_load_dwordx4 v[188:191], v114, s[28:31], s79 offen sc1
    v_mfma_f32_16x16x32_bf16 v[56:59], a[52:55], v[220:223], v[56:59]
    ds_write_b128 v112, v[48:51] offset:12288
    v_mfma_f32_16x16x32_bf16 v[60:63], a[56:59], v[220:223], v[60:63]
    v_mfma_f32_16x16x32_bf16 v[64:67], a[60:63], v[220:223], v[64:67]
    s_waitcnt vmcnt(13)
    v_mfma_f32_16x16x32_bf16 v[52:55], a[64:67], v[224:227], v[52:55]
    s_mul_i32 s54, s7, s101
    s_add_u32 m0, s55, 8192
    s_nop 0
    buffer_load_dwordx4 v16, s[16:19], s54 offen offset:0 sc1 lds
    v_mfma_f32_16x16x32_bf16 v[56:59], a[68:71], v[224:227], v[56:59]
    s_waitcnt lgkmcnt(0)
    s_barrier
    v_mfma_f32_16x16x32_bf16 v[60:63], a[72:75], v[224:227], v[60:63]
    ds_read_b128 v[68:71], v113 offset:12288
    v_mfma_f32_16x16x32_bf16 v[64:67], a[76:79], v[224:227], v[64:67]
    ds_read_b128 v[72:75], v113 offset:13312
    s_waitcnt vmcnt(13)
    v_mfma_f32_16x16x32_bf16 v[52:55], a[80:83], v[228:231], v[52:55]
    buffer_load_dwordx4 v17, s[16:19], s54 offen offset:1024 sc1 lds
    v_mfma_f32_16x16x32_bf16 v[56:59], a[84:87], v[228:231], v[56:59]
    ds_read_b128 v[76:79], v113 offset:14336
    v_mfma_f32_16x16x32_bf16 v[60:63], a[88:91], v[228:231], v[60:63]
    v_mfma_f32_16x16x32_bf16 v[64:67], a[92:95], v[228:231], v[64:67]
    s_waitcnt vmcnt(13)
    v_mfma_f32_16x16x32_bf16 v[52:55], a[96:99], v[232:235], v[52:55]
    buffer_load_dwordx4 v18, s[16:19], s54 offen offset:2048 sc1 lds
    v_mfma_f32_16x16x32_bf16 v[56:59], a[100:103], v[232:235], v[56:59]
    s_waitcnt lgkmcnt(2)
    v_add_f32 v36, v36, v68
    v_add_f32 v37, v37, v69
    v_add_f32 v38, v38, v70
    v_add_f32 v39, v39, v71
    v_mfma_f32_16x16x32_bf16 v[60:63], a[104:107], v[232:235], v[60:63]
    s_waitcnt lgkmcnt(1)
    v_add_f32 v36, v36, v72
    v_add_f32 v37, v37, v73
    v_add_f32 v38, v38, v74
    v_add_f32 v39, v39, v75
    v_mfma_f32_16x16x32_bf16 v[64:67], a[108:111], v[232:235], v[64:67]
    s_waitcnt lgkmcnt(0)
    v_add_f32 v36, v36, v76
    v_add_f32 v37, v37, v77
    v_add_f32 v38, v38, v78
    v_add_f32 v39, v39, v79
    s_waitcnt vmcnt(13)
    v_mfma_f32_16x16x32_bf16 v[52:55], a[112:115], v[236:239], v[52:55]
    buffer_load_dwordx4 v19, s[16:19], s54 offen offset:3072 sc1 lds
    v_mfma_f32_16x16x32_bf16 v[56:59], a[116:119], v[236:239], v[56:59]
    v_mul_f32 v68, v36, v36
    v_mul_f32 v69, v37, v37
    v_mfma_f32_16x16x32_bf16 v[60:63], a[120:123], v[236:239], v[60:63]
    v_mul_f32 v70, v38, v38
    v_mul_f32 v71, v39, v39
    v_mfma_f32_16x16x32_bf16 v[64:67], a[124:127], v[236:239], v[64:67]
    v_fma_f32 v68, v68, s58, v130
    s_waitcnt vmcnt(13)
    v_mfma_f32_16x16x32_bf16 v[52:55], a[128:131], v[240:243], v[52:55]
    s_mul_i32 s54, s8, s101
    s_add_u32 m0, s55, 12288
    s_nop 0
    buffer_load_dwordx4 v16, s[16:19], s54 offen offset:0 sc1 lds
    v_mfma_f32_16x16x32_bf16 v[56:59], a[132:135], v[240:243], v[56:59]
    v_fma_f32 v69, v69, s58, v130
    v_fma_f32 v70, v70, s58, v130
    v_mfma_f32_16x16x32_bf16 v[60:63], a[136:139], v[240:243], v[60:63]
    v_fma_f32 v71, v71, s58, v130
    v_mul_f32 v68, v68, v36
    v_mfma_f32_16x16x32_bf16 v[64:67], a[140:143], v[240:243], v[64:67]
    v_mul_f32 v69, v69, v37
    s_waitcnt vmcnt(13)
    v_mfma_f32_16x16x32_bf16 v[52:55], a[144:147], v[244:247], v[52:55]
    buffer_load_dwordx4 v17, s[16:19], s54 offen offset:1024 sc1 lds
    v_mfma_f32_16x16x32_bf16 v[56:59], a[148:151], v[244:247], v[56:59]
    v_mul_f32 v70, v70, v38
    v_mul_f32 v71, v71, v39
    v_mfma_f32_16x16x32_bf16 v[60:63], a[152:155], v[244:247], v[60:63]
    v_exp_f32 v68, v68
    v_mfma_f32_16x16x32_bf16 v[64:67], a[156:159], v[244:247], v[64:67]
    v_exp_f32 v69, v69
    s_waitcnt vmcnt(12)
    v_mfma_f32_16x16x32_bf16 v[52:55], a[160:163], v[248:251], v[52:55]
    buffer_load_dwordx4 v18, s[16:19], s54 offen offset:2048 sc1 lds
    v_mfma_f32_16x16x32_bf16 v[56:59], a[164:167], v[248:251], v[56:59]
    v_exp_f32 v70, v70
    v_mfma_f32_16x16x32_bf16 v[60:63], a[168:171], v[248:251], v[60:63]
    v_exp_f32 v71, v71
    v_add_f32 v68, 1.0, v68
    v_mfma_f32_16x16x32_bf16 v[64:67], a[172:175], v[248:251], v[64:67]
    v_add_f32 v69, 1.0, v69
    s_waitcnt vmcnt(12)
    v_mfma_f32_16x16x32_bf16 v[52:55], a[176:179], v[252:255], v[52:55]
    buffer_load_dwordx4 v19, s[16:19], s54 offen offset:3072 sc1 lds
    v_mfma_f32_16x16x32_bf16 v[56:59], a[180:183], v[252:255], v[56:59]
    v_add_f32 v70, 1.0, v70
    v_add_f32 v71, 1.0, v71
    v_mfma_f32_16x16x32_bf16 v[60:63], a[184:187], v[252:255], v[60:63]
    v_rcp_f32 v68, v68
    v_mfma_f32_16x16x32_bf16 v[64:67], a[188:191], v[252:255], v[64:67]
    v_rcp_f32 v69, v69
    s_waitcnt vmcnt(11)
    v_mfma_f32_16x16x32_bf16 v[52:55], a[192:195], v[176:179], v[52:55]
    s_mul_i32 s54, s9, s101
    s_add_u32 m0, s55, 16384
    s_nop 0
    buffer_load_dwordx4 v16, s[16:19], s54 offen offset:0 sc1 lds
    v_mfma_f32_16x16x32_bf16 v[56:59], a[196:199], v[176:179], v[56:59]
    v_rcp_f32 v70, v70
    v_mfma_f32_16x16x32_bf16 v[60:63], a[200:203], v[176:179], v[60:63]
    v_rcp_f32 v71, v71
    v_mfma_f32_16x16x32_bf16 v[64:67], a[204:207], v[176:179], v[64:67]
    v_mul_f32 v68, v68, v36
    s_waitcnt vmcnt(11)
    v_mfma_f32_16x16x32_bf16 v[52:55], a[208:211], v[180:183], v[52:55]
    buffer_load_dwordx4 v17, s[16:19], s54 offen offset:1024 sc1 lds
    v_mfma_f32_16x16x32_bf16 v[56:59], a[212:215], v[180:183], v[56:59]
    s_mov_b64 exec, 15
    buffer_atomic_add v5, v137, s[28:31], s89 offen sc1
    s_mov_b64 exec, -1
    v_mfma_f32_16x16x32_bf16 v[60:63], a[216:219], v[180:183], v[60:63]
    v_mul_f32 v69, v69, v37
    v_mul_f32 v70, v70, v38
    v_mfma_f32_16x16x32_bf16 v[64:67], a[220:223], v[180:183], v[64:67]
    v_mul_f32 v71, v71, v39
    s_waitcnt vmcnt(12)
    v_mfma_f32_16x16x32_bf16 v[52:55], a[224:227], v[184:187], v[52:55]
    buffer_load_dwordx4 v18, s[16:19], s54 offen offset:2048 sc1 lds
    v_mfma_f32_16x16x32_bf16 v[56:59], a[228:231], v[184:187], v[56:59]
    v_cvt_pk_bf16_f32 v132, v68, v69
    v_cvt_pk_bf16_f32 v133, v70, v71
    v_mfma_f32_16x16x32_bf16 v[60:63], a[232:235], v[184:187], v[60:63]
    v_cvt_pk_bf16_f32 v134, v68, v69
    v_cvt_pk_bf16_f32 v135, v70, v71
    v_mfma_f32_16x16x32_bf16 v[64:67], a[236:239], v[184:187], v[64:67]
    v_permlane32_swap_b32 v132, v134
    s_waitcnt vmcnt(12)
    v_mfma_f32_16x16x32_bf16 v[52:55], a[240:243], v[188:191], v[52:55]
    buffer_load_dwordx4 v19, s[16:19], s54 offen offset:3072 sc1 lds
    v_mfma_f32_16x16x32_bf16 v[56:59], a[244:247], v[188:191], v[56:59]
    v_permlane32_swap_b32 v133, v135
    v_mfma_f32_16x16x32_bf16 v[60:63], a[248:251], v[188:191], v[60:63]
    s_mov_b32 exec_hi, 0
    buffer_store_dwordx4 v[132:135], v4, s[28:31], s98 offen sc1
    s_mov_b32 exec_hi, -1
    v_mfma_f32_16x16x32_bf16 v[64:67], a[252:255], v[188:191], v[64:67]
L_p4b_29:
    s_nop 1
    ds_write_b128 v110, v[56:59] offset:0
    s_nop 0
    ds_write_b128 v111, v[60:63] offset:0
    s_nop 2
    ds_write_b128 v112, v[64:67] offset:0
    s_mul_i32 s54, s10, s101
    s_add_u32 m0, s52, 0
    s_nop 0
    buffer_load_dwordx4 v16, s[16:19], s54 offen offset:0 sc1 lds
    buffer_load_dwordx4 v17, s[16:19], s54 offen offset:1024 sc1 lds
    s_waitcnt lgkmcnt(0)
    s_barrier
    ds_read_b128 v[68:71], v113 offset:0
    ds_read_b128 v[72:75], v113 offset:1024
    ds_read_b128 v[76:79], v113 offset:2048
    buffer_load_dwordx4 v18, s[16:19], s54 offen offset:2048 sc1 lds
    buffer_load_dwordx4 v19, s[16:19], s54 offen offset:3072 sc1 lds
    s_waitcnt lgkmcnt(2)
    v_pk_add_f32 v[52:53], v[52:53], v[68:69]
    v_pk_add_f32 v[54:55], v[54:55], v[70:71]
    s_waitcnt lgkmcnt(1)
    v_pk_add_f32 v[52:53], v[52:53], v[72:73]
    v_pk_add_f32 v[54:55], v[54:55], v[74:75]
    s_waitcnt lgkmcnt(0)
    v_pk_add_f32 v[52:53], v[52:53], v[76:77]
    v_pk_add_f32 v[54:55], v[54:55], v[78:79]
    v_mul_f32 v68, v52, v52
    v_mul_f32 v69, v53, v53
    v_mul_f32 v70, v54, v54
    v_mul_f32 v71, v55, v55
    v_fma_f32 v68, v68, s58, v130
    v_fma_f32 v69, v69, s58, v130
    v_fma_f32 v70, v70, s58, v130
    v_fma_f32 v71, v71, s58, v130
    v_mul_f32 v68, v68, v52
    v_mul_f32 v69, v69, v53
    v_mul_f32 v70, v70, v54
    v_mul_f32 v71, v71, v55
    v_exp_f32 v68, v68
    v_exp_f32 v69, v69
    v_exp_f32 v70, v70
    v_exp_f32 v71, v71
    v_add_f32 v68, 1.0, v68
    v_add_f32 v69, 1.0, v69
    v_add_f32 v70, 1.0, v70
    v_add_f32 v71, 1.0, v71
    v_rcp_f32 v68, v68
    v_rcp_f32 v69, v69
    v_rcp_f32 v70, v70
    v_rcp_f32 v71, v71
    v_mul_f32 v68, v68, v52
    v_mul_f32 v69, v69, v53
    v_mul_f32 v70, v70, v54
    v_mul_f32 v71, v71, v55
    v_cvt_pk_bf16_f32 v132, v68, v69
    v_cvt_pk_bf16_f32 v133, v70, v71
    v_cvt_pk_bf16_f32 v134, v68, v69
    v_cvt_pk_bf16_f32 v135, v70, v71
    s_nop 0
    v_permlane32_swap_b32 v132, v134
    v_permlane32_swap_b32 v133, v135
    s_mov_b32 exec_hi, 0
    buffer_store_dwordx4 v[132:135], v4, s[28:31], s99 offen sc1
    s_mov_b32 exec_hi, -1
    s_mul_i32 s54, s11, s101
    s_add_u32 m0, s52, 4096
    s_nop 0
    buffer_load_dwordx4 v16, s[16:19], s54 offen offset:0 sc1 lds
    buffer_load_dwordx4 v17, s[16:19], s54 offen offset:1024 sc1 lds
    buffer_load_dwordx4 v18, s[16:19], s54 offen offset:2048 sc1 lds
    buffer_load_dwordx4 v19, s[16:19], s54 offen offset:3072 sc1 lds
    s_waitcnt vmcnt(9)
    s_mov_b64 exec, 15
    buffer_atomic_add v5, v137, s[28:31], s90 offen sc1
    s_mov_b64 exec, -1
    v_mov_b32 v118, 0
    s_mov_b64 exec, 3
    buffer_atomic_add v118, v117, s[28:31], s37 offen sc0 sc1
    s_mov_b64 exec, -1
    ds_read_b64_tr_b16 a[0:1], v20 offset:8192
    ds_read_b64_tr_b16 a[2:3], v20 offset:9216
    ds_read_b64_tr_b16 a[4:5], v21 offset:8192
    ds_read_b64_tr_b16 a[6:7], v21 offset:9216
    ds_read_b64_tr_b16 a[8:9], v22 offset:8192
    ds_read_b64_tr_b16 a[10:11], v22 offset:9216
    ds_read_b64_tr_b16 a[12:13], v23 offset:8192
    ds_read_b64_tr_b16 a[14:15], v23 offset:9216
    ds_read_b64_tr_b16 a[16:17], v24 offset:0
    ds_read_b64_tr_b16 a[18:19], v24 offset:1024
    ds_read_b64_tr_b16 a[20:21], v25 offset:0
    ds_read_b64_tr_b16 a[22:23], v25 offset:1024
    ds_read_b64_tr_b16 a[24:25], v26 offset:0
    ds_read_b64_tr_b16 a[26:27], v26 offset:1024
    ds_read_b64_tr_b16 a[28:29], v27 offset:0
    ds_read_b64_tr_b16 a[30:31], v27 offset:1024
    s_waitcnt lgkmcnt(8)
    s_mul_i32 s54, s20, s101
    s_add_u32 m0, s52, 8192
    s_nop 0
    buffer_load_dwordx4 v16, s[16:19], s54 offen offset:0 sc1 lds
    buffer_load_dwordx4 v17, s[16:19], s54 offen offset:1024 sc1 lds
    buffer_load_dwordx4 v18, s[16:19], s54 offen offset:2048 sc1 lds
    buffer_load_dwordx4 v19, s[16:19], s54 offen offset:3072 sc1 lds
    ds_read_b64_tr_b16 a[32:33], v24 offset:4096
    ds_read_b64_tr_b16 a[34:35], v24 offset:5120
    ds_read_b64_tr_b16 a[36:37], v25 offset:4096
    ds_read_b64_tr_b16 a[38:39], v25 offset:5120
    ds_read_b64_tr_b16 a[40:41], v26 offset:4096
    ds_read_b64_tr_b16 a[42:43], v26 offset:5120
    ds_read_b64_tr_b16 a[44:45], v27 offset:4096
    ds_read_b64_tr_b16 a[46:47], v27 offset:5120
    s_waitcnt lgkmcnt(8)
    s_mul_i32 s54, s21, s101
    s_add_u32 m0, s55, 0
    s_nop 0
    buffer_load_dwordx4 v16, s[16:19], s54 offen offset:0 sc1 lds
    buffer_load_dwordx4 v17, s[16:19], s54 offen offset:1024 sc1 lds
    buffer_load_dwordx4 v18, s[16:19], s54 offen offset:2048 sc1 lds
    buffer_load_dwordx4 v19, s[16:19], s54 offen offset:3072 sc1 lds
    s_waitcnt lgkmcnt(0)
    s_mul_i32 s54, s22, s101
    s_add_u32 m0, s55, 4096
    s_nop 0
    buffer_load_dwordx4 v16, s[16:19], s54 offen offset:0 sc1 lds
    buffer_load_dwordx4 v17, s[16:19], s54 offen offset:1024 sc1 lds
    buffer_load_dwordx4 v18, s[16:19], s54 offen offset:2048 sc1 lds
    buffer_load_dwordx4 v19, s[16:19], s54 offen offset:3072 sc1 lds
    ds_read_b64_tr_b16 a[48:49], v24 offset:8192
    ds_read_b64_tr_b16 a[50:51], v24 offset:9216
    ds_read_b64_tr_b16 a[52:53], v25 offset:8192
    ds_read_b64_tr_b16 a[54:55], v25 offset:9216
    ds_read_b64_tr_b16 a[56:57], v26 offset:8192
    ds_read_b64_tr_b16 a[58:59], v26 offset:9216
    ds_read_b64_tr_b16 a[60:61], v27 offset:8192
    ds_read_b64_tr_b16 a[62:63], v27 offset:9216
    s_waitcnt lgkmcnt(0)
    s_mul_i32 s54, s23, s101
    s_add_u32 m0, s55, 8192
    s_nop 0
    buffer_load_dwordx4 v16, s[16:19], s54 offen offset:0 sc1 lds
    buffer_load_dwordx4 v17, s[16:19], s54 offen offset:1024 sc1 lds
    buffer_load_dwordx4 v18, s[16:19], s54 offen offset:2048 sc1 lds
    buffer_load_dwordx4 v19, s[16:19], s54 offen offset:3072 sc1 lds
    s_waitcnt vmcnt(16)
    v_cmp_gt_u32 vcc, 24, v118
    s_mov_b32 s57, 0
    s_and_b32 vcc_lo, vcc_lo, 3
    s_cbranch_scc1 L_slow_E0_32
L_back_E0_33:
    buffer_load_dwordx4 v[192:195], v131, s[28:31], s4 offen sc1
    buffer_load_dwordx4 v[196:199], v131, s[28:31], s5 offen sc1
    buffer_load_dwordx4 v[200:203], v131, s[28:31], s6 offen sc1
    buffer_load_dwordx4 v[204:207], v131, s[28:31], s7 offen sc1
    buffer_load_dwordx4 v[208:211], v131, s[28:31], s8 offen sc1
    buffer_load_dwordx4 v[212:215], v131, s[28:31], s9 offen sc1
    s_mov_b64 exec, 15
    buffer_atomic_add v5, v137, s[28:31], s91 offen sc1
    s_mov_b64 exec, -1
    ds_read_b64_tr_b16 a[64:65], v24 offset:12288
    ds_read_b64_tr_b16 a[66:67], v24 offset:13312
    ds_read_b64_tr_b16 a[68:69], v25 offset:12288
    ds_read_b64_tr_b16 a[70:71], v25 offset:13312
    ds_read_b64_tr_b16 a[72:73], v26 offset:12288
    ds_read_b64_tr_b16 a[74:75], v26 offset:13312
    ds_read_b64_tr_b16 a[76:77], v27 offset:12288
    ds_read_b64_tr_b16 a[78:79], v27 offset:13312
    ds_read_b64_tr_b16 a[80:81], v24 offset:16384
    ds_read_b64_tr_b16 a[82:83], v24 offset:17408
    ds_read_b64_tr_b16 a[84:85], v25 offset:16384
    ds_read_b64_tr_b16 a[86:87], v25 offset:17408
    ds_read_b64_tr_b16 a[88:89], v26 offset:16384
    ds_read_b64_tr_b16 a[90:91], v26 offset:17408
    ds_read_b64_tr_b16 a[92:93], v27 offset:16384
    ds_read_b64_tr_b16 a[94:95], v27 offset:17408
    ds_read_b64_tr_b16 a[96:97], v20 offset:0
    ds_read_b64_tr_b16 a[98:99], v20 offset:1024
    ds_read_b64_tr_b16 a[100:101], v21 offset:0
    ds_read_b64_tr_b16 a[102:103], v21 offset:1024
    ds_read_b64_tr_b16 a[104:105], v22 offset:0
    ds_read_b64_tr_b16 a[106:107], v22 offset:1024
    ds_read_b64_tr_b16 a[108:109], v23 offset:0
    ds_read_b64_tr_b16 a[110:111], v23 offset:1024
    ds_read_b64_tr_b16 a[112:113], v20 offset:4096
    ds_read_b64_tr_b16 a[114:115], v20 offset:5120
    ds_read_b64_tr_b16 a[116:117], v21 offset:4096
    ds_read_b64_tr_b16 a[118:119], v21 offset:5120
    ds_read_b64_tr_b16 a[120:121], v22 offset:4096
    ds_read_b64_tr_b16 a[122:123], v22 offset:5120
    ds_read_b64_tr_b16 a[124:125], v23 offset:4096
    ds_read_b64_tr_b16 a[126:127], v23 offset:5120
    buffer_load_dwordx4 v[216:219], v131, s[28:31], s10 offen sc1
    buffer_load_dwordx4 v[220:223], v131, s[28:31], s11 offen sc1
    buffer_load_dwordx4 v[224:227], v131, s[28:31], s20 offen sc1
    buffer_load_dwordx4 v[228:231], v131, s[28:31], s21 offen sc1
    buffer_load_dwordx4 v[232:235], v131, s[28:31], s22 offen sc1
    buffer_load_dwordx4 v[236:239], v131, s[28:31], s23 offen sc1
    s_waitcnt vmcnt(25)
    ds_read_b64_tr_b16 a[128:129], v20 offset:8192
    ds_read_b64_tr_b16 a[130:131], v20 offset:9216
    ds_read_b64_tr_b16 a[132:133], v21 offset:8192
    ds_read_b64_tr_b16 a[134:135], v21 offset:9216
    ds_read_b64_tr_b16 a[136:137], v22 offset:8192
    ds_read_b64_tr_b16 a[138:139], v22 offset:9216
    ds_read_b64_tr_b16 a[140:141], v23 offset:8192
    ds_read_b64_tr_b16 a[142:143], v23 offset:9216
    s_waitcnt vmcnt(21)
    ds_read_b64_tr_b16 a[144:145], v24 offset:0
    ds_read_b64_tr_b16 a[146:147], v24 offset:1024
    ds_read_b64_tr_b16 a[148:149], v25 offset:0
    ds_read_b64_tr_b16 a[150:151], v25 offset:1024
    ds_read_b64_tr_b16 a[152:153], v26 offset:0
    ds_read_b64_tr_b16 a[154:155], v26 offset:1024
    ds_read_b64_tr_b16 a[156:157], v27 offset:0
    ds_read_b64_tr_b16 a[158:159], v27 offset:1024
    s_waitcnt vmcnt(17)
    ds_read_b64_tr_b16 a[160:161], v24 offset:4096
    ds_read_b64_tr_b16 a[162:163], v24 offset:5120
    ds_read_b64_tr_b16 a[164:165], v25 offset:4096
    ds_read_b64_tr_b16 a[166:167], v25 offset:5120
    ds_read_b64_tr_b16 a[168:169], v26 offset:4096
    ds_read_b64_tr_b16 a[170:171], v26 offset:5120
    ds_read_b64_tr_b16 a[172:173], v27 offset:4096
    ds_read_b64_tr_b16 a[174:175], v27 offset:5120
    s_waitcnt vmcnt(13)
    ds_read_b64_tr_b16 a[176:177], v24 offset:8192
    ds_read_b64_tr_b16 a[178:179], v24 offset:9216
    ds_read_b64_tr_b16 a[180:181], v25 offset:8192
    ds_read_b64_tr_b16 a[182:183], v25 offset:9216
    ds_read_b64_tr_b16 a[184:185], v26 offset:8192
    ds_read_b64_tr_b16 a[186:187], v26 offset:9216
    ds_read_b64_tr_b16 a[188:189], v27 offset:8192
    ds_read_b64_tr_b16 a[190:191], v27 offset:9216
    s_waitcnt lgkmcnt(0)
    v_mfma_f32_16x16x16_bf16 v[36:39], v[100:101], v[128:129], v[124:127]
    s_waitcnt vmcnt(12)
    v_mfma_f32_16x16x32_bf16 v[40:43], v[192:195], a[4:7], 0
    v_add_u32 v131, 49152, v131
    buffer_load_dwordx4 v[240:243], v131, s[28:31], s4 offen sc1
    v_mfma_f32_16x16x32_bf16 v[44:47], v[192:195], a[8:11], 0
    v_mfma_f32_16x16x32_bf16 v[48:51], v[192:195], a[12:15], 0
    v_mfma_f32_16x16x32_bf16 v[36:39], v[192:195], a[0:3], v[36:39]
    s_waitcnt vmcnt(12)
    v_mfma_f32_16x16x32_bf16 v[40:43], v[196:199], a[20:23], v[40:43]
    buffer_load_dwordx4 v[244:247], v131, s[28:31], s5 offen sc1
    v_mfma_f32_16x16x32_bf16 v[44:47], v[196:199], a[24:27], v[44:47]
    v_mov_b32 v118, 0
    s_mov_b64 exec, 4
    buffer_atomic_add v118, v117, s[28:31], s37 offen sc0 sc1
    s_mov_b64 exec, -1
    v_mfma_f32_16x16x32_bf16 v[48:51], v[196:199], a[28:31], v[48:51]
    v_mfma_f32_16x16x32_bf16 v[36:39], v[196:199], a[16:19], v[36:39]
    s_waitcnt vmcnt(13)
    v_mfma_f32_16x16x32_bf16 v[40:43], v[200:203], a[36:39], v[40:43]
    buffer_load_dwordx4 v[248:251], v131, s[28:31], s6 offen sc1
    v_mfma_f32_16x16x32_bf16 v[44:47], v[200:203], a[40:43], v[44:47]
    v_mfma_f32_16x16x32_bf16 v[48:51], v[200:203], a[44:47], v[48:51]
    v_mfma_f32_16x16x32_bf16 v[36:39], v[200:203], a[32:35], v[36:39]
    s_waitcnt vmcnt(13)
    v_mfma_f32_16x16x32_bf16 v[40:43], v[204:207], a[52:55], v[40:43]
    buffer_load_dwordx4 v[252:255], v131, s[28:31], s7 offen sc1
    v_mfma_f32_16x16x32_bf16 v[44:47], v[204:207], a[56:59], v[44:47]
    v_mfma_f32_16x16x32_bf16 v[48:51], v[204:207], a[60:63], v[48:51]
    v_mfma_f32_16x16x32_bf16 v[36:39], v[204:207], a[48:51], v[36:39]
    s_waitcnt vmcnt(13)
    v_mfma_f32_16x16x32_bf16 v[40:43], v[208:211], a[68:71], v[40:43]
    buffer_load_dwordx4 v[176:179], v131, s[28:31], s8 offen sc1
    v_mfma_f32_16x16x32_bf16 v[44:47], v[208:211], a[72:75], v[44:47]
    v_mfma_f32_16x16x32_bf16 v[48:51], v[208:211], a[76:79], v[48:51]
    v_mfma_f32_16x16x32_bf16 v[36:39], v[208:211], a[64:67], v[36:39]
    s_waitcnt vmcnt(13)
    v_mfma_f32_16x16x32_bf16 v[40:43], v[212:215], a[84:87], v[40:43]
    buffer_load_dwordx4 v[180:183], v131, s[28:31], s9 offen sc1
    v_mfma_f32_16x16x32_bf16 v[44:47], v[212:215], a[88:91], v[44:47]
    v_mfma_f32_16x16x32_bf16 v[48:51], v[212:215], a[92:95], v[48:51]
    v_mfma_f32_16x16x32_bf16 v[36:39], v[212:215], a[80:83], v[36:39]
    s_waitcnt vmcnt(12)
    v_mfma_f32_16x16x32_bf16 v[40:43], v[216:219], a[100:103], v[40:43]
    buffer_load_dwordx4 v[184:187], v131, s[28:31], s10 offen sc1
    v_mfma_f32_16x16x32_bf16 v[44:47], v[216:219], a[104:107], v[44:47]
    v_mfma_f32_16x16x32_bf16 v[48:51], v[216:219], a[108:111], v[48:51]
    v_mfma_f32_16x16x32_bf16 v[36:39], v[216:219], a[96:99], v[36:39]
    s_waitcnt vmcnt(12)
    v_mfma_f32_16x16x32_bf16 v[40:43], v[220:223], a[116:119], v[40:43]
    buffer_load_dwordx4 v[188:191], v131, s[28:31], s11 offen sc1
    v_mfma_f32_16x16x32_bf16 v[44:47], v[220:223], a[120:123], v[44:47]
    v_mfma_f32_16x16x32_bf16 v[48:51], v[220:223], a[124:127], v[48:51]
    v_mfma_f32_16x16x32_bf16 v[36:39], v[220:223], a[112:115], v[36:39]
    s_waitcnt vmcnt(12)
    v_mfma_f32_16x16x32_bf16 v[40:43], v[224:227], a[132:135], v[40:43]
    buffer_load_dwordx4 v[192:195], v131, s[28:31], s20 offen sc1
    v_mfma_f32_16x16x32_bf16 v[44:47], v[224:227], a[136:139], v[44:47]
    v_mfma_f32_16x16x32_bf16 v[48:51], v[224:227], a[140:143], v[48:51]
    v_mfma_f32_16x16x32_bf16 v[36:39], v[224:227], a[128:131], v[36:39]
    s_waitcnt vmcnt(12)
    v_mfma_f32_16x16x32_bf16 v[40:43], v[228:231], a[148:151], v[40:43]
    buffer_load_dwordx4 v[196:199], v131, s[28:31], s21 offen sc1
    v_mfma_f32_16x16x32_bf16 v[44:47], v[228:231], a[152:155], v[44:47]
    v_mfma_f32_16x16x32_bf16 v[48:51], v[228:231], a[156:159], v[48:51]
    v_mfma_f32_16x16x32_bf16 v[36:39], v[228:231], a[144:147], v[36:39]
    s_waitcnt vmcnt(12)
    v_mfma_f32_16x16x32_bf16 v[40:43], v[232:235], a[164:167], v[40:43]
    buffer_load_dwordx4 v[200:203], v131, s[28:31], s22 offen sc1
    v_mfma_f32_16x16x32_bf16 v[44:47], v[232:235], a[168:171], v[44:47]
    v_mfma_f32_16x16x32_bf16 v[48:51], v[232:235], a[172:175], v[48:51]
    v_mfma_f32_16x16x32_bf16 v[36:39], v[232:235], a[160:163], v[36:39]
    s_waitcnt vmcnt(12)
    v_mfma_f32_16x16x32_bf16 v[40:43], v[236:239], a[180:183], v[40:43]
    buffer_load_dwordx4 v[204:207], v131, s[28:31], s23 offen sc1
    v_mfma_f32_16x16x16_bf16 v[52:55], v[102:103], v[128:129], v[124:127]
    v_mfma_f32_16x16x32_bf16 v[44:47], v[236:239], a[184:187], v[44:47]
    v_mfma_f32_16x16x32_bf16 v[48:51], v[236:239], a[188:191], v[48:51]
    v_mfma_f32_16x16x32_bf16 v[36:39], v[236:239], a[176:179], v[36:39]
    s_waitcnt vmcnt(10)
    v_cmp_gt_u32 vcc, 24, v118
    s_mov_b32 s57, 0
    s_and_b32 vcc_lo, vcc_lo, 4
    s_cbranch_scc1 L_slow_E2_34
L_back_E2_35:
    v_mfma_f32_16x16x32_bf16 v[56:59], v[240:243], a[4:7], 0
    v_add_u32 v131, 49152, v131
    buffer_load_dwordx4 v[208:211], v131, s[28:31], s4 offen sc1
    v_mfma_f32_16x16x32_bf16 v[60:63], v[240:243], a[8:11], 0
    v_mfma_f32_16x16x32_bf16 v[64:67], v[240:243], a[12:15], 0
    v_mfma_f32_16x16x32_bf16 v[52:55], v[240:243], a[0:3], v[52:55]
    v_mfma_f32_16x16x32_bf16 v[56:59], v[244:247], a[20:23], v[56:59]
    buffer_load_dwordx4 v[212:215], v131, s[28:31], s5 offen sc1
    v_mfma_f32_16x16x32_bf16 v[60:63], v[244:247], a[24:27], v[60:63]
    v_mov_b32 v118, 0
    s_mov_b64 exec, 8
    buffer_atomic_add v118, v117, s[28:31], s37 offen sc0 sc1
    s_mov_b64 exec, -1
    ds_write_b128 v110, v[40:43] offset:12288
    v_mfma_f32_16x16x32_bf16 v[64:67], v[244:247], a[28:31], v[64:67]
    v_mfma_f32_16x16x32_bf16 v[52:55], v[244:247], a[16:19], v[52:55]
    s_waitcnt vmcnt(12)
    v_mfma_f32_16x16x32_bf16 v[56:59], v[248:251], a[36:39], v[56:59]
    buffer_load_dwordx4 v[216:219], v131, s[28:31], s6 offen sc1
    v_mfma_f32_16x16x32_bf16 v[60:63], v[248:251], a[40:43], v[60:63]
    ds_write_b128 v111, v[44:47] offset:12288
    v_mfma_f32_16x16x32_bf16 v[64:67], v[248:251], a[44:47], v[64:67]
    v_mfma_f32_16x16x32_bf16 v[52:55], v[248:251], a[32:35], v[52:55]
    s_waitcnt vmcnt(12)
    v_mfma_f32_16x16x32_bf16 v[56:59], v[252:255], a[52:55], v[56:59]
    buffer_load_dwordx4 v[220:223], v131, s[28:31], s7 offen sc1
    v_mfma_f32_16x16x32_bf16 v[60:63], v[252:255], a[56:59], v[60:63]
    ds_write_b128 v112, v[48:51] offset:12288
    v_mfma_f32_16x16x32_bf16 v[64:67], v[252:255], a[60:63], v[64:67]
    v_mfma_f32_16x16x32_bf16 v[52:55], v[252:255], a[48:51], v[52:55]
    s_waitcnt vmcnt(12)
    v_mfma_f32_16x16x32_bf16 v[56:59], v[176:179], a[68:71], v[56:59]
    buffer_load_dwordx4 v[224:227], v131, s[28:31], s8 offen sc1
    v_mfma_f32_16x16x32_bf16 v[60:63], v[176:179], a[72:75], v[60:63]
    s_waitcnt lgkmcnt(0)
    s_barrier
    v_mfma_f32_16x16x32_bf16 v[64:67], v[176:179], a[76:79], v[64:67]
    ds_read_b128 v[68:71], v113 offset:12288
    v_mfma_f32_16x16x32_bf16 v[52:55], v[176:179], a[64:67], v[52:55]
    ds_read_b128 v[72:75], v113 offset:13312
    s_waitcnt vmcnt(12)
    v_mfma_f32_16x16x32_bf16 v[56:59], v[180:183], a[84:87], v[56:59]
    buffer_load_dwordx4 v[228:231], v131, s[28:31], s9 offen sc1
    v_mfma_f32_16x16x32_bf16 v[60:63], v[180:183], a[88:91], v[60:63]
    ds_read_b128 v[76:79], v113 offset:14336
    v_mfma_f32_16x16x32_bf16 v[64:67], v[180:183], a[92:95], v[64:67]
    v_mfma_f32_16x16x32_bf16 v[52:55], v[180:183], a[80:83], v[52:55]
    s_waitcnt vmcnt(12)
    v_mfma_f32_16x16x32_bf16 v[56:59], v[184:187], a[100:103], v[56:59]
    buffer_load_dwordx4 v[232:235], v131, s[28:31], s10 offen sc1
    v_mfma_f32_16x16x32_bf16 v[60:63], v[184:187], a[104:107], v[60:63]
    s_waitcnt lgkmcnt(2)
    v_add_f32 v36, v36, v68
    v_add_f32 v37, v37, v69
    v_mfma_f32_16x16x32_bf16 v[64:67], v[184:187], a[108:111], v[64:67]
    v_add_f32 v38, v38, v70
    v_add_f32 v39, v39, v71
    v_mfma_f32_16x16x32_bf16 v[52:55], v[184:187], a[96:99], v[52:55]
    s_waitcnt lgkmcnt(1)
    v_add_f32 v36, v36, v72
    s_waitcnt vmcnt(12)
    v_mfma_f32_16x16x32_bf16 v[56:59], v[188:191], a[116:119], v[56:59]
    buffer_load_dwordx4 v[236:239], v131, s[28:31], s11 offen sc1
    v_mfma_f32_16x16x32_bf16 v[60:63], v[188:191], a[120:123], v[60:63]
    v_add_f32 v37, v37, v73
    v_add_f32 v38, v38, v74
    v_mfma_f32_16x16x32_bf16 v[64:67], v[188:191], a[124:127], v[64:67]
    v_add_f32 v39, v39, v75
    s_waitcnt lgkmcnt(0)
    v_mfma_f32_16x16x32_bf16 v[52:55], v[188:191], a[112:115], v[52:55]
    v_add_f32 v36, v36, v76
    s_waitcnt vmcnt(12)
    v_mfma_f32_16x16x32_bf16 v[56:59], v[192:195], a[132:135], v[56:59]
    buffer_load_dwordx4 v[240:243], v131, s[28:31], s20 offen sc1
    v_mfma_f32_16x16x32_bf16 v[60:63], v[192:195], a[136:139], v[60:63]
    v_add_f32 v37, v37, v77
    v_add_f32 v38, v38, v78
    v_mfma_f32_16x16x32_bf16 v[64:67], v[192:195], a[140:143], v[64:67]
    v_add_f32 v39, v39, v79
    v_cvt_pk_bf16_f32 v132, v36, v37
    v_mfma_f32_16x16x32_bf16 v[52:55], v[192:195], a[128:131], v[52:55]
    v_cvt_pk_bf16_f32 v133, v38, v39
    s_waitcnt vmcnt(12)
    v_mfma_f32_16x16x32_bf16 v[56:59], v[196:199], a[148:151], v[56:59]
    buffer_load_dwordx4 v[244:247], v131, s[28:31], s21 offen sc1
    v_mfma_f32_16x16x32_bf16 v[60:63], v[196:199], a[152:155], v[60:63]
    ds_write_b64 v141, v[132:133] offset:0
    v_mfma_f32_16x16x32_bf16 v[64:67], v[196:199], a[156:159], v[64:67]
    v_mfma_f32_16x16x32_bf16 v[52:55], v[196:199], a[144:147], v[52:55]
    s_waitcnt vmcnt(12)
    v_mfma_f32_16x16x32_bf16 v[56:59], v[200:203], a[164:167], v[56:59]
    buffer_load_dwordx4 v[248:251], v131, s[28:31], s22 offen sc1
    v_mfma_f32_16x16x32_bf16 v[60:63], v[200:203], a[168:171], v[60:63]
    v_mfma_f32_16x16x32_bf16 v[64:67], v[200:203], a[172:175], v[64:67]
    v_mfma_f32_16x16x32_bf16 v[52:55], v[200:203], a[160:163], v[52:55]
    s_waitcnt vmcnt(12)
    v_mfma_f32_16x16x32_bf16 v[56:59], v[204:207], a[180:183], v[56:59]
    buffer_load_dwordx4 v[252:255], v131, s[28:31], s23 offen sc1
    v_mfma_f32_16x16x16_bf16 v[36:39], v[104:105], v[128:129], v[124:127]
    v_mfma_f32_16x16x32_bf16 v[60:63], v[204:207], a[184:187], v[60:63]
    v_mfma_f32_16x16x32_bf16 v[64:67], v[204:207], a[188:191], v[64:67]
    v_mfma_f32_16x16x32_bf16 v[52:55], v[204:207], a[176:179], v[52:55]
    s_waitcnt vmcnt(10)
    v_cmp_gt_u32 vcc, 24, v118
    s_mov_b32 s57, 0
    s_and_b32 vcc_lo, vcc_lo, 8
    s_cbranch_scc1 L_slow_E3_36
L_back_E3_37:
    v_mfma_f32_16x16x32_bf16 v[40:43], v[208:211], a[4:7], 0
    v_add_u32 v131, 49152, v131
    buffer_load_dwordx4 v[176:179], v131, s[28:31], s4 offen sc1
    v_mfma_f32_16x16x32_bf16 v[44:47], v[208:211], a[8:11], 0
    v_mfma_f32_16x16x32_bf16 v[48:51], v[208:211], a[12:15], 0
    v_mfma_f32_16x16x32_bf16 v[36:39], v[208:211], a[0:3], v[36:39]
    v_mfma_f32_16x16x32_bf16 v[40:43], v[212:215], a[20:23], v[40:43]
    buffer_load_dwordx4 v[180:183], v131, s[28:31], s5 offen sc1
    v_mfma_f32_16x16x32_bf16 v[44:47], v[212:215], a[24:27], v[44:47]
    v_mov_b32 v118, 0
    s_mov_b64 exec, 16
    buffer_atomic_add v118, v117, s[28:31], s37 offen sc0 sc1
    s_mov_b64 exec, -1
    ds_write_b128 v110, v[56:59] offset:0
    v_mfma_f32_16x16x32_bf16 v[48:51], v[212:215], a[28:31], v[48:51]
    v_mfma_f32_16x16x32_bf16 v[36:39], v[212:215], a[16:19], v[36:39]
    s_waitcnt vmcnt(12)
    v_mfma_f32_16x16x32_bf16 v[40:43], v[216:219], a[36:39], v[40:43]
    buffer_load_dwordx4 v[184:187], v131, s[28:31], s6 offen sc1
    v_mfma_f32_16x16x32_bf16 v[44:47], v[216:219], a[40:43], v[44:47]
    ds_write_b128 v111, v[60:63] offset:0
    v_mfma_f32_16x16x32_bf16 v[48:51], v[216:219], a[44:47], v[48:51]
    v_mfma_f32_16x16x32_bf16 v[36:39], v[216:219], a[32:35], v[36:39]
    s_waitcnt vmcnt(12)
    v_mfma_f32_16x16x32_bf16 v[40:43], v[220:223], a[52:55], v[40:43]
    buffer_load_dwordx4 v[188:191], v131, s[28:31], s7 offen sc1
    v_mfma_f32_16x16x32_bf16 v[44:47], v[220:223], a[56:59], v[44:47]
    ds_write_b128 v112, v[64:67] offset:0
    v_mfma_f32_16x16x32_bf16 v[48:51], v[220:223], a[60:63], v[48:51]
    v_mfma_f32_16x16x32_bf16 v[36:39], v[220:223], a[48:51], v[36:39]
    s_waitcnt vmcnt(12)
    v_mfma_f32_16x16x32_bf16 v[40:43], v[224:227], a[68:71], v[40:43]
    buffer_load_dwordx4 v[192:195], v131, s[28:31], s8 offen sc1
    v_mfma_f32_16x16x32_bf16 v[44:47], v[224:227], a[72:75], v[44:47]
    s_waitcnt lgkmcnt(0)
    s_barrier
    v_mfma_f32_16x16x32_bf16 v[48:51], v[224:227], a[76:79], v[48:51]
    ds_read_b128 v[68:71], v113 offset:0
    v_mfma_f32_16x16x32_bf16 v[36:39], v[224:227], a[64:67], v[36:39]
    ds_read_b128 v[72:75], v113 offset:1024
    s_waitcnt vmcnt(12)
    v_mfma_f32_16x16x32_bf16 v[40:43], v[228:231], a[84:87], v[40:43]
    buffer_load_dwordx4 v[196:199], v131, s[28:31], s9 offen sc1
    v_mfma_f32_16x16x32_bf16 v[44:47], v[228:231], a[88:91], v[44:47]
    ds_read_b128 v[76:79], v113 offset:2048
    v_mfma_f32_16x16x32_bf16 v[48:51], v[228:231], a[92:95], v[48:51]
    v_mfma_f32_16x16x32_bf16 v[36:39], v[228:231], a[80:83], v[36:39]
    s_waitcnt vmcnt(12)
    v_mfma_f32_16x16x32_bf16 v[40:43], v[232:235], a[100:103], v[40:43]
    buffer_load_dwordx4 v[200:203], v131, s[28:31], s10 offen sc1
    v_mfma_f32_16x16x32_bf16 v[44:47], v[232:235], a[104:107], v[44:47]
    s_waitcnt lgkmcnt(2)
    v_add_f32 v52, v52, v68
    v_add_f32 v53, v53, v69
    v_mfma_f32_16x16x32_bf16 v[48:51], v[232:235], a[108:111], v[48:51]
    v_add_f32 v54, v54, v70
    v_add_f32 v55, v55, v71
    v_mfma_f32_16x16x32_bf16 v[36:39], v[232:235], a[96:99], v[36:39]
    s_waitcnt lgkmcnt(1)
    v_add_f32 v52, v52, v72
    s_waitcnt vmcnt(12)
    v_mfma_f32_16x16x32_bf16 v[40:43], v[236:239], a[116:119], v[40:43]
    buffer_load_dwordx4 v[204:207], v131, s[28:31], s11 offen sc1
    v_mfma_f32_16x16x32_bf16 v[44:47], v[236:239], a[120:123], v[44:47]
    v_add_f32 v53, v53, v73
    v_add_f32 v54, v54, v74
    v_mfma_f32_16x16x32_bf16 v[48:51], v[236:239], a[124:127], v[48:51]
    v_add_f32 v55, v55, v75
    s_waitcnt lgkmcnt(0)
    v_mfma_f32_16x16x32_bf16 v[36:39], v[236:239], a[112:115], v[36:39]
    v_add_f32 v52, v52, v76
    s_waitcnt vmcnt(12)
    v_mfma_f32_16x16x32_bf16 v[40:43], v[240:243], a[132:135], v[40:43]
    buffer_load_dwordx4 v[208:211], v131, s[28:31], s20 offen sc1
    v_mfma_f32_16x16x32_bf16 v[44:47], v[240:243], a[136:139], v[44:47]
    v_add_f32 v53, v53, v77
    v_add_f32 v54, v54, v78
    v_mfma_f32_16x16x32_bf16 v[48:51], v[240:243], a[140:143], v[48:51]
    v_add_f32 v55, v55, v79
    v_cvt_pk_bf16_f32 v132, v52, v53
    v_mfma_f32_16x16x32_bf16 v[36:39], v[240:243], a[128:131], v[36:39]
    v_cvt_pk_bf16_f32 v133, v54, v55
    s_waitcnt vmcnt(12)
    v_mfma_f32_16x16x32_bf16 v[40:43], v[244:247], a[148:151], v[40:43]
    buffer_load_dwordx4 v[212:215], v131, s[28:31], s21 offen sc1
    v_mfma_f32_16x16x32_bf16 v[44:47], v[244:247], a[152:155], v[44:47]
    ds_write_b64 v141, v[132:133] offset:32
    v_mfma_f32_16x16x32_bf16 v[48:51], v[244:247], a[156:159], v[48:51]
    v_mfma_f32_16x16x32_bf16 v[36:39], v[244:247], a[144:147], v[36:39]
    s_waitcnt vmcnt(12)
    v_mfma_f32_16x16x32_bf16 v[40:43], v[248:251], a[164:167], v[40:43]
    buffer_load_dwordx4 v[216:219], v131, s[28:31], s22 offen sc1
    v_mfma_f32_16x16x32_bf16 v[44:47], v[248:251], a[168:171], v[44:47]
    v_mfma_f32_16x16x32_bf16 v[48:51], v[248:251], a[172:175], v[48:51]
    v_mfma_f32_16x16x32_bf16 v[36:39], v[248:251], a[160:163], v[36:39]
    s_waitcnt vmcnt(12)
    v_mfma_f32_16x16x32_bf16 v[40:43], v[252:255], a[180:183], v[40:43]
    buffer_load_dwordx4 v[220:223], v131, s[28:31], s23 offen sc1
    v_mfma_f32_16x16x16_bf16 v[52:55], v[106:107], v[128:129], v[124:127]
    v_mfma_f32_16x16x32_bf16 v[44:47], v[252:255], a[184:187], v[44:47]
    v_mfma_f32_16x16x32_bf16 v[48:51], v[252:255], a[188:191], v[48:51]
    v_mfma_f32_16x16x32_bf16 v[36:39], v[252:255], a[176:179], v[36:39]
    s_waitcnt vmcnt(10)
    v_cmp_gt_u32 vcc, 24, v118
    s_mov_b32 s57, 0
    s_and_b32 vcc_lo, vcc_lo, 16
    s_cbranch_scc1 L_slow_E4_38
L_back_E4_39:
    v_mfma_f32_16x16x32_bf16 v[56:59], v[176:179], a[4:7], 0
    v_add_u32 v131, 49152, v131
    buffer_load_dwordx4 v[224:227], v131, s[28:31], s4 offen sc1
    v_mfma_f32_16x16x32_bf16 v[60:63], v[176:179], a[8:11], 0
    v_mfma_f32_16x16x32_bf16 v[64:67], v[176:179], a[12:15], 0
    v_mfma_f32_16x16x32_bf16 v[52:55], v[176:179], a[0:3], v[52:55]
    v_mfma_f32_16x16x32_bf16 v[56:59], v[180:183], a[20:23], v[56:59]
    buffer_load_dwordx4 v[228:231], v131, s[28:31], s5 offen sc1
    v_mfma_f32_16x16x32_bf16 v[60:63], v[180:183], a[24:27], v[60:63]
    ds_write_b128 v110, v[40:43] offset:12288
    v_mfma_f32_16x16x32_bf16 v[64:67], v[180:183], a[28:31], v[64:67]
    v_mfma_f32_16x16x32_bf16 v[52:55], v[180:183], a[16:19], v[52:55]
    s_waitcnt vmcnt(11)
    v_mfma_f32_16x16x32_bf16 v[56:59], v[184:187], a[36:39], v[56:59]
    buffer_load_dwordx4 v[232:235], v131, s[28:31], s6 offen sc1
    v_mfma_f32_16x16x32_bf16 v[60:63], v[184:187], a[40:43], v[60:63]
    ds_write_b128 v111, v[44:47] offset:12288
    v_mfma_f32_16x16x32_bf16 v[64:67], v[184:187], a[44:47], v[64:67]
    v_mfma_f32_16x16x32_bf16 v[52:55], v[184:187], a[32:35], v[52:55]
    s_waitcnt vmcnt(11)
    v_mfma_f32_16x16x32_bf16 v[56:59], v[188:191], a[52:55], v[56:59]
    buffer_load_dwordx4 v[236:239], v131, s[28:31], s7 offen sc1
    v_mfma_f32_16x16x32_bf16 v[60:63], v[188:191], a[56:59], v[60:63]
    ds_write_b128 v112, v[48:51] offset:12288
    v_mfma_f32_16x16x32_bf16 v[64:67], v[188:191], a[60:63], v[64:67]
    v_mfma_f32_16x16x32_bf16 v[52:55], v[188:191], a[48:51], v[52:55]
    s_waitcnt vmcnt(11)
    v_mfma_f32_16x16x32_bf16 v[56:59], v[192:195], a[68:71], v[56:59]
    buffer_load_dwordx4 v[240:243], v131, s[28:31], s8 offen sc1
    v_mfma_f32_16x16x32_bf16 v[60:63], v[192:195], a[72:75], v[60:63]
    s_waitcnt lgkmcnt(0)
    s_barrier
    v_mfma_f32_16x16x32_bf16 v[64:67], v[192:195], a[76:79], v[64:67]
    ds_read_b128 v[68:71], v113 offset:12288
    v_mfma_f32_16x16x32_bf16 v[52:55], v[192:195], a[64:67], v[52:55]
    ds_read_b128 v[72:75], v113 offset:13312
    s_waitcnt vmcnt(11)
    v_mfma_f32_16x16x32_bf16 v[56:59], v[196:199], a[84:87], v[56:59]
    buffer_load_dwordx4 v[244:247], v131, s[28:31], s9 offen sc1
    v_mfma_f32_16x16x32_bf16 v[60:63], v[196:199], a[88:91], v[60:63]
    ds_read_b128 v[76:79], v113 offset:14336
    v_mfma_f32_16x16x32_bf16 v[64:67], v[196:199], a[92:95], v[64:67]
    v_mfma_f32_16x16x32_bf16 v[52:55], v[196:199], a[80:83], v[52:55]
    s_waitcnt vmcnt(11)
    v_mfma_f32_16x16x32_bf16 v[56:59], v[200:203], a[100:103], v[56:59]
    buffer_load_dwordx4 v[248:251], v131, s[28:31], s10 offen sc1
    v_mfma_f32_16x16x32_bf16 v[60:63], v[200:203], a[104:107], v[60:63]
    s_waitcnt lgkmcnt(2)
    v_add_f32 v36, v36, v68
    v_add_f32 v37, v37, v69
    v_mfma_f32_16x16x32_bf16 v[64:67], v[200:203], a[108:111], v[64:67]
    v_add_f32 v38, v38, v70
    v_add_f32 v39, v39, v71
    v_mfma_f32_16x16x32_bf16 v[52:55], v[200:203], a[96:99], v[52:55]
    s_waitcnt lgkmcnt(1)
    v_add_f32 v36, v36, v72
    s_waitcnt vmcnt(11)
    v_mfma_f32_16x16x32_bf16 v[56:59], v[204:207], a[116:119], v[56:59]
    buffer_load_dwordx4 v[252:255], v131, s[28:31], s11 offen sc1
    v_mfma_f32_16x16x32_bf16 v[60:63], v[204:207], a[120:123], v[60:63]
    v_add_f32 v37, v37, v73
    v_add_f32 v38, v38, v74
    v_mfma_f32_16x16x32_bf16 v[64:67], v[204:207], a[124:127], v[64:67]
    v_add_f32 v39, v39, v75
    s_waitcnt lgkmcnt(0)
    v_mfma_f32_16x16x32_bf16 v[52:55], v[204:207], a[112:115], v[52:55]
    v_add_f32 v36, v36, v76
    s_waitcnt vmcnt(11)
    v_mfma_f32_16x16x32_bf16 v[56:59], v[208:211], a[132:135], v[56:59]
    buffer_load_dwordx4 v[176:179], v131, s[28:31], s20 offen sc1
    v_mfma_f32_16x16x32_bf16 v[60:63], v[208:211], a[136:139], v[60:63]
    v_add_f32 v37, v37, v77
    v_add_f32 v38, v38, v78
    v_mfma_f32_16x16x32_bf16 v[64:67], v[208:211], a[140:143], v[64:67]
    v_add_f32 v39, v39, v79
    v_cvt_pk_bf16_f32 v132, v36, v37
    v_mfma_f32_16x16x32_bf16 v[52:55], v[208:211], a[128:131], v[52:55]
    v_cvt_pk_bf16_f32 v133, v38, v39
    s_waitcnt vmcnt(11)
    v_mfma_f32_16x16x32_bf16 v[56:59], v[212:215], a[148:151], v[56:59]
    buffer_load_dwordx4 v[180:183], v131, s[28:31], s21 offen sc1
    v_mfma_f32_16x16x32_bf16 v[60:63], v[212:215], a[152:155], v[60:63]
    ds_write_b64 v141, v[132:133] offset:64
    v_mfma_f32_16x16x32_bf16 v[64:67], v[212:215], a[156:159], v[64:67]
    v_mfma_f32_16x16x32_bf16 v[52:55], v[212:215], a[144:147], v[52:55]
    s_waitcnt vmcnt(11)
    v_mfma_f32_16x16x32_bf16 v[56:59], v[216:219], a[164:167], v[56:59]
    buffer_load_dwordx4 v[184:187], v131, s[28:31], s22 offen sc1
    v_mfma_f32_16x16x32_bf16 v[60:63], v[216:219], a[168:171], v[60:63]
    v_mfma_f32_16x16x32_bf16 v[64:67], v[216:219], a[172:175], v[64:67]
    v_mfma_f32_16x16x32_bf16 v[52:55], v[216:219], a[160:163], v[52:55]
    s_waitcnt vmcnt(11)
    v_mfma_f32_16x16x32_bf16 v[56:59], v[220:223], a[180:183], v[56:59]
    buffer_load_dwordx4 v[188:191], v131, s[28:31], s23 offen sc1
    v_mfma_f32_16x16x16_bf16 v[36:39], v[108:109], v[128:129], v[124:127]
    v_mfma_f32_16x16x32_bf16 v[60:63], v[220:223], a[184:187], v[60:63]
    v_mfma_f32_16x16x32_bf16 v[64:67], v[220:223], a[188:191], v[64:67]
    v_mfma_f32_16x16x32_bf16 v[52:55], v[220:223], a[176:179], v[52:55]
    s_waitcnt vmcnt(11)
    v_mfma_f32_16x16x32_bf16 v[40:43], v[224:227], a[4:7], 0
    v_mfma_f32_16x16x32_bf16 v[44:47], v[224:227], a[8:11], 0
    v_mfma_f32_16x16x32_bf16 v[48:51], v[224:227], a[12:15], 0
    ds_write_b128 v110, v[56:59] offset:0
    v_mfma_f32_16x16x32_bf16 v[36:39], v[224:227], a[0:3], v[36:39]
    s_waitcnt vmcnt(10)
    v_mfma_f32_16x16x32_bf16 v[40:43], v[228:231], a[20:23], v[40:43]
    v_mfma_f32_16x16x32_bf16 v[44:47], v[228:231], a[24:27], v[44:47]
    ds_write_b128 v111, v[60:63] offset:0
    v_mfma_f32_16x16x32_bf16 v[48:51], v[228:231], a[28:31], v[48:51]
    v_mfma_f32_16x16x32_bf16 v[36:39], v[228:231], a[16:19], v[36:39]
    s_waitcnt vmcnt(9)
    v_mfma_f32_16x16x32_bf16 v[40:43], v[232:235], a[36:39], v[40:43]
    ds_write_b128 v112, v[64:67] offset:0
    v_mfma_f32_16x16x32_bf16 v[44:47], v[232:235], a[40:43], v[44:47]
    v_mfma_f32_16x16x32_bf16 v[48:51], v[232:235], a[44:47], v[48:51]
    s_waitcnt lgkmcnt(0)
    s_barrier
    v_mfma_f32_16x16x32_bf16 v[36:39], v[232:235], a[32:35], v[36:39]
    ds_read_b128 v[68:71], v113 offset:0
    s_waitcnt vmcnt(8)
    v_mfma_f32_16x16x32_bf16 v[40:43], v[236:239], a[52:55], v[40:43]
    ds_read_b128 v[72:75], v113 offset:1024
    v_mfma_f32_16x16x32_bf16 v[44:47], v[236:239], a[56:59], v[44:47]
    ds_read_b128 v[76:79], v113 offset:2048
    v_mfma_f32_16x16x32_bf16 v[48:51], v[236:239], a[60:63], v[48:51]
    v_mfma_f32_16x16x32_bf16 v[36:39], v[236:239], a[48:51], v[36:39]
    s_waitcnt vmcnt(7)
    v_mfma_f32_16x16x32_bf16 v[40:43], v[240:243], a[68:71], v[40:43]
    s_waitcnt lgkmcnt(2)
    v_add_f32 v52, v52, v68
    v_add_f32 v53, v53, v69
    v_mfma_f32_16x16x32_bf16 v[44:47], v[240:243], a[72:75], v[44:47]
    v_add_f32 v54, v54, v70
    v_add_f32 v55, v55, v71
    v_mfma_f32_16x16x32_bf16 v[48:51], v[240:243], a[76:79], v[48:51]
    s_waitcnt lgkmcnt(1)
    v_add_f32 v52, v52, v72
    v_add_f32 v53, v53, v73
    v_add_f32 v54, v54, v74
    v_mfma_f32_16x16x32_bf16 v[36:39], v[240:243], a[64:67], v[36:39]
    v_add_f32 v55, v55, v75
    s_waitcnt vmcnt(6)
    v_mfma_f32_16x16x32_bf16 v[40:43], v[244:247], a[84:87], v[40:43]
    s_waitcnt lgkmcnt(0)
    v_add_f32 v52, v52, v76
    s_waitcnt vmcnt(5)
    v_mfma_f32_16x16x32_bf16 v[40:43], v[248:251], a[100:103], v[40:43]
    v_add_f32 v53, v53, v77
    s_waitcnt vmcnt(4)
    v_mfma_f32_16x16x32_bf16 v[40:43], v[252:255], a[116:119], v[40:43]
    v_add_f32 v54, v54, v78
    s_waitcnt vmcnt(3)
    v_mfma_f32_16x16x32_bf16 v[40:43], v[176:179], a[132:135], v[40:43]
    v_add_f32 v55, v55, v79
    s_waitcnt vmcnt(2)
    v_mfma_f32_16x16x32_bf16 v[40:43], v[180:183], a[148:151], v[40:43]
    v_cvt_pk_bf16_f32 v132, v52, v53
    s_waitcnt vmcnt(1)
    v_mfma_f32_16x16x32_bf16 v[40:43], v[184:187], a[164:167], v[40:43]
    v_cvt_pk_bf16_f32 v133, v54, v55
    s_waitcnt vmcnt(0)
    v_mfma_f32_16x16x32_bf16 v[40:43], v[188:191], a[180:183], v[40:43]
    ds_write_b64 v141, v[132:133] offset:96
    v_mfma_f32_16x16x32_bf16 v[44:47], v[244:247], a[88:91], v[44:47]
    ds_read_b128 v[144:147], v142 offset:0
    v_mfma_f32_16x16x32_bf16 v[44:47], v[248:251], a[104:107], v[44:47]
    ds_read_b128 v[148:151], v142 offset:1152
    v_mfma_f32_16x16x32_bf16 v[44:47], v[252:255], a[120:123], v[44:47]
    s_nop 1
    ds_write_b128 v110, v[40:43] offset:12288
    v_mfma_f32_16x16x32_bf16 v[44:47], v[176:179], a[136:139], v[44:47]
    v_mfma_f32_16x16x32_bf16 v[44:47], v[180:183], a[152:155], v[44:47]
    v_mfma_f32_16x16x32_bf16 v[44:47], v[184:187], a[168:171], v[44:47]
    v_mfma_f32_16x16x32_bf16 v[44:47], v[188:191], a[184:187], v[44:47]
    s_waitcnt lgkmcnt(2)
    buffer_store_dwordx4 v[144:147], v143, s[24:27], 0 offen sc1
    v_mfma_f32_16x16x32_bf16 v[48:51], v[244:247], a[92:95], v[48:51]
    v_mfma_f32_16x16x32_bf16 v[48:51], v[248:251], a[108:111], v[48:51]
    s_nop 2
    v_mfma_f32_16x16x32_bf16 v[48:51], v[252:255], a[124:127], v[48:51]
    ds_write_b128 v111, v[44:47] offset:12288
    v_mfma_f32_16x16x32_bf16 v[48:51], v[176:179], a[140:143], v[48:51]
    v_mfma_f32_16x16x32_bf16 v[48:51], v[180:183], a[156:159], v[48:51]
    s_waitcnt lgkmcnt(2)
    buffer_store_dwordx4 v[148:151], v143, s[24:27], s53 offen sc1
    v_mfma_f32_16x16x32_bf16 v[48:51], v[184:187], a[172:175], v[48:51]
    v_mfma_f32_16x16x32_bf16 v[48:51], v[188:191], a[188:191], v[48:51]
    v_mfma_f32_16x16x32_bf16 v[36:39], v[244:247], a[80:83], v[36:39]
    s_nop 1
    v_mfma_f32_16x16x32_bf16 v[36:39], v[248:251], a[96:99], v[36:39]
    s_nop 2
    v_mfma_f32_16x16x32_bf16 v[36:39], v[252:255], a[112:115], v[36:39]
    ds_write_b128 v112, v[48:51] offset:12288
    v_mfma_f32_16x16x32_bf16 v[36:39], v[176:179], a[128:131], v[36:39]
    v_mfma_f32_16x16x32_bf16 v[36:39], v[180:183], a[144:147], v[36:39]
    v_mfma_f32_16x16x32_bf16 v[36:39], v[184:187], a[160:163], v[36:39]
    v_mfma_f32_16x16x32_bf16 v[36:39], v[188:191], a[176:179], v[36:39]
    s_waitcnt lgkmcnt(0)
    s_barrier
    ds_read_b128 v[68:71], v113 offset:12288
    ds_read_b128 v[72:75], v113 offset:13312
    ds_read_b128 v[76:79], v113 offset:14336
    s_waitcnt lgkmcnt(2)
    s_nop 1
    v_pk_add_f32 v[36:37], v[36:37], v[68:69]
    v_pk_add_f32 v[38:39], v[38:39], v[70:71]
    s_waitcnt lgkmcnt(1)
    v_pk_add_f32 v[36:37], v[36:37], v[72:73]
    v_pk_add_f32 v[38:39], v[38:39], v[74:75]
    s_waitcnt lgkmcnt(0)
    v_pk_add_f32 v[36:37], v[36:37], v[76:77]
    v_pk_add_f32 v[38:39], v[38:39], v[78:79]
    v_cvt_pk_bf16_f32 v132, v36, v37
    v_cvt_pk_bf16_f32 v133, v38, v39
    v_cvt_pk_bf16_f32 v134, v36, v37
    v_cvt_pk_bf16_f32 v135, v38, v39
    s_nop 0
    v_permlane16_swap_b32 v132, v134
    v_permlane16_swap_b32 v133, v135
    s_mov_b32 exec_lo, 0xffff
    s_mov_b32 exec_hi, 0xffff
    buffer_store_dwordx4 v[132:135], v115, s[24:27], 0 offen offset:128 sc1
    s_mov_b64 exec, -1
L_fin:
L_end:
    s_endpgm
L_gospin_3:
    s_sleep 6
    s_mov_b64 exec, 0xf
    global_load_dword v50, v32, s[36:37] offset:0 sc1
    s_mov_b64 exec, -1
    s_add_u32 s57, s57, 1
    s_waitcnt vmcnt(0)
    v_cmp_ne_u32 vcc, 1, v50
    s_bitcmp1_b32 s57, 19
    s_cbranch_scc1 L_go_2
    s_and_b32 vcc_lo, vcc_lo, 0xf
    s_cbranch_scc1 L_gospin_3
    s_branch L_go_2
L_slow_P_4:
    s_sleep 1
    v_mov_b32 v51, 0
    s_mov_b64 exec, 1
    buffer_atomic_add v51, v6, s[28:31], s73 offen sc0 sc1
    s_mov_b64 exec, -1
    s_add_u32 s57, s57, 1
    s_waitcnt vmcnt(0)
    v_cmp_gt_u32 vcc, 15, v51
    s_bitcmp1_b32 s57, 19
    s_cbranch_scc1 L_back_P_5
    s_and_b32 vcc_lo, vcc_lo, 1
    s_cbranch_scc1 L_slow_P_4
    s_branch L_back_P_5
L_gospin_7:
    s_sleep 6
    s_mov_b64 exec, 0x7ff
    global_load_dword v50, v32, s[36:37] offset:128 sc1
    s_mov_b64 exec, -1
    s_add_u32 s57, s57, 1
    s_waitcnt vmcnt(0)
    v_cmp_ne_u32 vcc, 1, v50
    s_bitcmp1_b32 s57, 19
    s_cbranch_scc1 L_go_6
    s_and_b32 vcc_lo, vcc_lo, 0x7ff
    s_cbranch_scc1 L_gospin_7
    s_branch L_go_6
L_slow_O_8:
    s_sleep 1
    v_mov_b32 v51, 0
    s_mov_b64 exec, 1
    buffer_atomic_add v51, v6, s[28:31], s74 offen sc0 sc1
    s_mov_b64 exec, -1
    s_add_u32 s57, s57, 1
    s_waitcnt vmcnt(0)
    v_cmp_gt_u32 vcc, 25, v51
    s_bitcmp1_b32 s57, 19
    s_cbranch_scc1 L_back_O_9
    s_and_b32 vcc_lo, vcc_lo, 1
    s_cbranch_scc1 L_slow_O_8
    s_branch L_back_O_9
L_slow_A2_12:
    s_sleep 1
    v_mov_b32 v50, 0
    s_mov_b64 exec, 1
    buffer_atomic_add v50, v6, s[28:31], s90 offen sc0 sc1
    s_mov_b64 exec, -1
    s_add_u32 s57, s57, 1
    s_waitcnt vmcnt(0)
    v_cmp_gt_u32 vcc, 65535, v50
    s_bitcmp1_b32 s57, 19
    s_cbranch_scc1 L_back_A2_13
    s_and_b32 vcc_lo, vcc_lo, 1
    s_cbranch_scc1 L_slow_A2_12
    s_branch L_back_A2_13
L_regather_10:
    s_waitcnt vmcnt(3)
    v_cmp_gt_u32 vcc, 65535, v50
    s_mov_b32 s57, 0
    s_and_b32 vcc_lo, vcc_lo, 1
    s_cbranch_scc1 L_slow_A2_12
L_back_A2_13:
    s_sub_u32 s3, s91, 4096
    s_andn2_b32 s57, 0x3, s0
    s_cbranch_scc0 L_have_14
    buffer_load_dwordx4 v[152:155], v4, s[28:31], s3 offen offset:0 sc1
L_have_14:
    s_andn2_b32 s57, 0xc, s0
    s_cbranch_scc0 L_have_15
    buffer_load_dwordx4 v[156:159], v4, s[28:31], s3 offen offset:1024 sc1
L_have_15:
    s_andn2_b32 s57, 0x30, s0
    s_cbranch_scc0 L_have_16
    buffer_load_dwordx4 v[160:163], v4, s[28:31], s3 offen offset:2048 sc1
L_have_16:
    s_andn2_b32 s57, 0xc0, s0
    s_cbranch_scc0 L_have_17
    buffer_load_dwordx4 v[164:167], v4, s[28:31], s3 offen offset:3072 sc1
L_have_17:
    s_add_u32 s3, s3, 4096
    s_andn2_b32 s57, 0x300, s0
    s_cbranch_scc0 L_have_18
    buffer_load_dwordx4 v[168:171], v4, s[28:31], s3 offen offset:0 sc1
L_have_18:
    s_andn2_b32 s57, 0xc00, s0
    s_cbranch_scc0 L_have_19
    buffer_load_dwordx4 v[172:175], v4, s[28:31], s3 offen offset:1024 sc1
L_have_19:
    s_andn2_b32 s57, 0x3000, s0
    s_cbranch_scc0 L_have_20
    buffer_load_dwordx4 v[176:179], v4, s[28:31], s3 offen offset:2048 sc1
L_have_20:
    s_andn2_b32 s57, 0xc000, s0
    s_cbranch_scc0 L_have_21
    buffer_load_dwordx4 v[180:183], v4, s[28:31], s3 offen offset:3072 sc1
L_have_21:
    s_branch L_gathered_11
L_slow_X_22:
    s_sleep 1
    v_mov_b32 v61, 0
    s_mov_b64 exec, 1
    buffer_atomic_add v61, v6, s[28:31], s33 offen sc0 sc1
    s_mov_b64 exec, -1
    s_add_u32 s57, s57, 1
    s_waitcnt vmcnt(0)
    v_cmp_gt_u32 vcc, s34, v61
    s_bitcmp1_b32 s57, 19
    s_cbranch_scc1 L_back_X_23
    s_and_b32 vcc_lo, vcc_lo, 1
    s_cbranch_scc1 L_slow_X_22
    s_branch L_back_X_23
L_slow_B_24:
    s_sleep 1
    v_mov_b32 v10, 0
    s_mov_b64 exec, 1
    buffer_atomic_add v10, v6, s[28:31], s39 offen sc0 sc1
    s_mov_b64 exec, -1
    s_add_u32 s57, s57, 1
    s_waitcnt vmcnt(0)
    v_cmp_gt_u32 vcc, 16, v10
    s_bitcmp1_b32 s57, 19
    s_cbranch_scc1 L_back_B_25
    s_and_b32 vcc_lo, vcc_lo, 1
    s_cbranch_scc1 L_slow_B_24
    s_branch L_back_B_25
L_slow_C_26:
    buffer_load_dwordx4 v[68:71], v34, s[28:31], s50 offen sc1
    s_add_u32 s57, s57, 1
    s_waitcnt vmcnt(0)
    v_max_u32 v9, v68, v69
    v_max3_u32 v9, v9, v70, v71
    v_cmp_eq_u32 vcc, -1, v9
    s_bitcmp1_b32 s57, 19
    s_cbranch_scc1 L_back_C_27
    s_cbranch_vccnz L_slow_C_26
    s_branch L_back_C_27
L_slow_D_30:
    s_sleep 1
    v_mov_b32 v118, 0
    s_mov_b64 exec, 3
    buffer_atomic_add v118, v116, s[28:31], s36 offen sc0 sc1
    s_mov_b64 exec, -1
    s_add_u32 s57, s57, 1
    s_waitcnt vmcnt(0)
    v_cmp_gt_u32 vcc, 8, v118
    s_bitcmp1_b32 s57, 19
    s_cbranch_scc1 L_back_D_31
    s_and_b32 vcc_lo, vcc_lo, 3
    s_cbranch_scc1 L_slow_D_30
    s_branch L_back_D_31
L_p4_28:
    s_waitcnt vmcnt(0) lgkmcnt(0)
    s_mul_i32 s54, s7, s101
    s_add_u32 m0, s55, 8192
    s_nop 0
    buffer_load_dwordx4 v16, s[16:19], s54 offen offset:0 sc1 lds
    buffer_load_dwordx4 v17, s[16:19], s54 offen offset:1024 sc1 lds
    buffer_load_dwordx4 v18, s[16:19], s54 offen offset:2048 sc1 lds
    buffer_load_dwordx4 v19, s[16:19], s54 offen offset:3072 sc1 lds
    s_mul_i32 s54, s8, s101
    s_add_u32 m0, s55, 12288
    s_nop 0
    buffer_load_dwordx4 v16, s[16:19], s54 offen offset:0 sc1 lds
    buffer_load_dwordx4 v17, s[16:19], s54 offen offset:1024 sc1 lds
    buffer_load_dwordx4 v18, s[16:19], s54 offen offset:2048 sc1 lds
    buffer_load_dwordx4 v19, s[16:19], s54 offen offset:3072 sc1 lds
    s_mul_i32 s54, s9, s101
    s_add_u32 m0, s55, 16384
    s_nop 0
    buffer_load_dwordx4 v16, s[16:19], s54 offen offset:0 sc1 lds
    buffer_load_dwordx4 v17, s[16:19], s54 offen offset:1024 sc1 lds
    buffer_load_dwordx4 v18, s[16:19], s54 offen offset:2048 sc1 lds
    buffer_load_dwordx4 v19, s[16:19], s54 offen offset:3072 sc1 lds
    s_waitcnt vmcnt(0)
    s_branch L_p4b_29
L_slow_E0_32:
    s_sleep 1
    v_mov_b32 v118, 0
    s_mov_b64 exec, 3
    buffer_atomic_add v118, v117, s[28:31], s37 offen sc0 sc1
    s_mov_b64 exec, -1
    s_add_u32 s57, s57, 1
    s_waitcnt vmcnt(0)
    v_cmp_gt_u32 vcc, 24, v118
    s_bitcmp1_b32 s57, 19
    s_cbranch_scc1 L_back_E0_33
    s_and_b32 vcc_lo, vcc_lo, 3
    s_cbranch_scc1 L_slow_E0_32
    s_branch L_back_E0_33
L_slow_E2_34:
    s_sleep 1
    v_mov_b32 v118, 0
    s_mov_b64 exec, 4
    buffer_atomic_add v118, v117, s[28:31], s37 offen sc0 sc1
    s_mov_b64 exec, -1
    s_add_u32 s57, s57, 1
    s_waitcnt vmcnt(0)
    v_cmp_gt_u32 vcc, 24, v118
    s_bitcmp1_b32 s57, 19
    s_cbranch_scc1 L_back_E2_35
    s_and_b32 vcc_lo, vcc_lo, 4
    s_cbranch_scc1 L_slow_E2_34
    s_branch L_back_E2_35
L_slow_E3_36:
    s_sleep 1
    v_mov_b32 v118, 0
    s_mov_b64 exec, 8
    buffer_atomic_add v118, v117, s[28:31], s37 offen sc0 sc1
    s_mov_b64 exec, -1
    s_add_u32 s57, s57, 1
    s_waitcnt vmcnt(0)
    v_cmp_gt_u32 vcc, 24, v118
    s_bitcmp1_b32 s57, 19
    s_cbranch_scc1 L_back_E3_37
    s_and_b32 vcc_lo, vcc_lo, 8
    s_cbranch_scc1 L_slow_E3_36
    s_branch L_back_E3_37
L_slow_E4_38:
    s_sleep 1
    v_mov_b32 v118, 0
    s_mov_b64 exec, 16
    buffer_atomic_add v118, v117, s[28:31], s37 offen sc0 sc1
    s_mov_b64 exec, -1
    s_add_u32 s57, s57, 1
    s_waitcnt vmcnt(0)
    v_cmp_gt_u32 vcc, 24, v118
    s_bitcmp1_b32 s57, 19
    s_cbranch_scc1 L_back_E4_39
    s_and_b32 vcc_lo, vcc_lo, 16
    s_cbranch_scc1 L_slow_E4_38
    s_branch L_back_E4_39
    .fill (66048 - (. - sequential_preLN__linear_attn_block__mixer_token_mlp__prompt_kernel)) / 4, 4, 0xbf810000
.section .rodata,"a"
.p2align 6
.amdhsa_kernel sequential_preLN__linear_attn_block__mixer_token_mlp__prompt_kernel
  .amdhsa_next_free_vgpr 512
  .amdhsa_next_free_sgpr 102
  .amdhsa_accum_offset 256
  .amdhsa_group_segment_fixed_size 0
  .amdhsa_kernarg_size 88
  .amdhsa_user_sgpr_count 2
  .amdhsa_user_sgpr_kernarg_segment_ptr 1
  .amdhsa_system_sgpr_workgroup_id_x 1
.end_amdhsa_kernel
```
